```python
import torch

def _softmax(x, axis=-1):
    return torch.softmax(x, dim=axis)
def _gelu(x):
    return torch.nn.functional.gelu(x, approximate="tanh")
def _silu(x):
    return torch.nn.functional.silu(x)
def _sigmoid(x):
    return torch.sigmoid(x)
def _layernorm(x, axis=-1, eps=1e-5):
    m = x.mean(dim=axis, keepdim=True)
    v = x.var(dim=axis, keepdim=True, unbiased=False)
    return (x - m) / torch.sqrt(v + eps)
def _scatter_add(tgt, idx, src, axis=0):
    return tgt.clone().index_add_(axis, idx, src)
def _segment_sum(src, seg, n):
    out = torch.zeros((n,) + src.shape[1:], dtype=src.dtype)
    return out.index_add_(0, seg, src)
def _pad(x, pw):
    flat = tuple(v for pair in reversed(pw) for v in pair)
    return torch.nn.functional.pad(x, flat)

kernel_name = 'recurrent_scan__spectral_fnet__geglu_ffn__prompt'

def setup_inputs():

    _w = (lambda a: (lambda t: t.to(torch.bfloat16) if t.is_floating_point() else t)(torch.as_tensor(a)))
    def _A_setup():
        B, S, D = 1, 2048, 448
        ns = torch.arange(S)[:, None] * torch.arange(S)[None, :]
        nd = torch.arange(D)[:, None] * torch.arange(D)[None, :]
        Ws_re = torch.cos(-2.0 * torch.pi * ns / S).to(float)
        Ws_im = torch.sin(-2.0 * torch.pi * ns / S).to(float)
        Wd_re = torch.cos(-2.0 * torch.pi * nd / D).to(float)
        Wd_im = torch.sin(-2.0 * torch.pi * nd / D).to(float)
        return {
            "x": _w((lambda *s: torch.randn(*s, dtype=torch.bfloat16) * 0.05)(B, S, D)),
            "dft_seq_re": _w(Ws_re),
            "dft_seq_im": _w(Ws_im),
            "dft_hid_re": _w(Wd_re),
            "dft_hid_im": _w(Wd_im),
        }
    _A_in = _A_setup()

    def _B_setup():
        B, S, D, F = 1, 2048, 448, 1792
        return {
            "x": _w((lambda *s: torch.randn(*s, dtype=torch.bfloat16) * 0.05)(B, S, D)),
            "w_gate": _w((lambda *s: torch.randn(*s, dtype=torch.bfloat16) * 0.05)(D, F)),
            "w_up": _w((lambda *s: torch.randn(*s, dtype=torch.bfloat16) * 0.05)(D, F)),
            "w_down": _w((lambda *s: torch.randn(*s, dtype=torch.bfloat16) * 0.05)(F, D)),
        }
    _B_in = _B_setup()

    return {
        "A_x": _A_in["x"],
        "A_dft_seq_re": _A_in["dft_seq_re"],
        "A_dft_seq_im": _A_in["dft_seq_im"],
        "A_dft_hid_re": _A_in["dft_hid_re"],
        "A_dft_hid_im": _A_in["dft_hid_im"],
        "B_x": _B_in["x"],
        "B_w_gate": _B_in["w_gate"],
        "B_w_up": _B_in["w_up"],
        "B_w_down": _B_in["w_down"],
    }

def reference(A_x, A_dft_seq_re, A_dft_seq_im, A_dft_hid_re, A_dft_hid_im, B_x, B_w_gate, B_w_up, B_w_down):
    def _A_ref(x, dft_seq_re, dft_seq_im, dft_hid_re, dft_hid_im):
        a = torch.einsum("bsd,ed->bse", x, dft_hid_re)
        b = torch.einsum("bsd,ed->bse", x, dft_hid_im)
        y = torch.einsum("ts,bse->bte", dft_seq_re, a) - torch.einsum("ts,bse->bte", dft_seq_im, b)
        return y

    def _B_ref(x, w_gate, w_up, w_down):
        return (_gelu(x @ w_gate) * (x @ w_up)) @ w_down

    x = A_x
    xn = _layernorm(x, axis=-1)
    s = _A_ref(xn, A_dft_seq_re, A_dft_seq_im, A_dft_hid_re, A_dft_hid_im)
    g = _silu(_B_ref(xn, B_w_gate, B_w_up, B_w_down))
    return x + s * g
```

```asm
; @launch grid=(256,1,1) block=(512,1,1) lds=163840
.amdgcn_target "amdgcn-amd-amdhsa--gfx950"
.text
.globl recurrent_scan__spectral_fnet__geglu_ffn__prompt_kernel
.p2align 8
.type recurrent_scan__spectral_fnet__geglu_ffn__prompt_kernel,@function
recurrent_scan__spectral_fnet__geglu_ffn__prompt_kernel:

    s_cmp_ge_u32 s2, 256
    s_cbranch_scc1 k_done
    s_load_dwordx16 s[16:31], s[0:1], 0
    s_load_dwordx8 s[32:39], s[0:1], 64
    s_memrealtime s[98:99]
    v_lshrrev_b32 v2, 6, v0
    v_and_b32 v1, 63, v0
    v_readfirstlane_b32 s60, v2
    s_bfe_u32 s71, s2, 0x20003
    s_lshr_b32 s64, s2, 5
    s_and_b32 s61, s2, 3
    s_lshl_b32 s61, s61, 2
    s_add_u32 s61, s61, s71
    s_and_b32 s65, s2, 7
    s_lshl_b32 s65, s65, 2
    s_lshr_b32 s67, 0x20536420, s65
    s_and_b32 s67, s67, 7
    s_add_u32 s65, s65, s71
    s_add_u32 s67, s67, s64
    s_sub_u32 s73, s67, 7
    s_cmp_ge_u32 s67, 7
    s_cselect_b32 s67, s73, s67
    s_bfe_u32 s72, s2, 0x10002
    s_mul_i32 s62, s72, 7
    s_add_u32 s62, s62, s64
    v_lshrrev_b32 v3, 4, v1
    v_lshrrev_b32 v4, 3, v1
    v_and_b32 v5, 7, v1
    v_lshlrev_b32 v2, 4, v1
    v_xor_b32 v6, v5, v3
    v_lshlrev_b32 v6, 4, v6
    v_mul_u32_u24 v7, 57344, v4
    v_add_u32 v20, v7, v6
    v_xor_b32 v21, 64, v20
    v_add_u32 v21, 457728, v21
    s_mul_i32 s68, s61, 3584
    s_mov_b32 s76, 0xffff0000
    s_cmp_eq_u32 s64, 7
    s_cbranch_scc0 k_ffn
    s_add_u32 s62, s72, 14
    v_and_b32 v5, 15, v1
    v_lshlrev_b32 v6, 2, v3
    v_xor_b32 v6, v5, v6
    v_lshlrev_b32 v6, 4, v6
    v_mul_u32_u24 v7, 896, v3
    v_add_u32 v22, v6, v7
    v_add_u32 v23, 2560, v22
    s_lshr_b32 s71, s60, 1
    s_mul_i32 s71, s71, 896
    s_add_u32 s68, s68, s71
    s_and_b32 s71, s60, 1
    s_mul_i32 s71, s71, 917504
    s_add_u32 s68, s68, s71
    s_mul_i32 s69, s60, 7168
    s_lshl_b32 s71, s72, 8
    s_add_u32 s69, s69, s71
    s_add_u32 s69, s69, 384
    s_lshl_b32 s70, s60, 11
    s_waitcnt lgkmcnt(0)
    s_mov_b32 s40, s16
    s_and_b32 s41, s17, 0xffff
    s_mov_b32 s42, 1835008
    s_mov_b32 s43, 0x20000
    s_mov_b32 s44, s22
    s_and_b32 s45, s23, 0xffff
    s_mov_b32 s46, 401408
    s_mov_b32 s47, 0x20000
    s_mov_b32 s48, s24
    s_and_b32 s49, s25, 0xffff
    s_mov_b32 s50, 401408
    s_mov_b32 s51, 0x20000
    s_add_u32 m0, s70, 0
    s_lshl_b32 s72, s67, 7
    s_add_u32 s72, s72, s68
    buffer_load_dwordx4 v20, s[40:43], s72 offen lds
    buffer_load_dwordx4 v21, s[40:43], s72 offen offset:1024 lds
    s_add_u32 m0, s70, 49152
    s_mul_i32 s73, s67, 57344
    s_add_u32 s73, s73, s69
    buffer_load_dwordx4 v22, s[44:47], s73 offen lds
    buffer_load_dwordx4 v23, s[44:47], s73 offen offset:1024 lds
    s_add_u32 m0, s70, 65536
    s_add_u32 s67, s67, 1
    buffer_load_dwordx4 v22, s[48:51], s73 offen lds
    buffer_load_dwordx4 v23, s[48:51], s73 offen offset:1024 lds
    s_cmp_eq_u32 s67, 7
    s_cselect_b32 s67, 0, s67
    s_branch k_dft
k_ffn:
    s_and_b32 s63, s60, 3
    v_and_b32 v6, 1, v3
    v_lshlrev_b32 v6, 2, v6
    v_xor_b32 v6, v5, v6
    v_lshlrev_b32 v6, 4, v6
    v_mul_u32_u24 v7, 3584, v4
    v_add_u32 v22, v6, v7
    v_add_u32 v23, 27648, v22
    s_mul_i32 s69, s63, 57344
    s_lshl_b32 s71, s62, 8
    s_add_u32 s69, s69, s71
    s_lshl_b32 s70, s63, 12
    s_lshl_b32 s3, s63, 11
    s_cmp_lt_u32 s60, 4
    s_cbranch_scc1 kA
    v_add_u32 v108, 915456, v20
    v_add_u32 v109, 915456, v21
    s_mul_i32 s71, s63, 896
    s_add_u32 s68, s68, s71
    s_waitcnt lgkmcnt(0)
    s_mov_b32 s40, s16
    s_and_b32 s41, s17, 0xffff
    s_mov_b32 s42, 1835008
    s_mov_b32 s43, 0x20000
    s_mov_b32 s44, s28
    s_and_b32 s45, s29, 0xffff
    s_mov_b32 s46, 1605632
    s_mov_b32 s47, 0x20000
    s_mov_b32 s48, s30
    s_and_b32 s49, s31, 0xffff
    s_mov_b32 s50, 1605632
    s_mov_b32 s51, 0x20000
    s_add_u32 m0, s70, 0
    s_lshl_b32 s72, s67, 7
    s_add_u32 s72, s72, s68
    buffer_load_dwordx4 v20, s[40:43], s72 offen offset:0 lds
    buffer_load_dwordx4 v21, s[40:43], s72 offen offset:1024 lds
    buffer_load_dwordx4 v108, s[40:43], s72 offen offset:2048 lds
    buffer_load_dwordx4 v109, s[40:43], s72 offen offset:3072 lds
    s_add_u32 m0, s3, 49152
    s_mul_i32 s73, s67, 229376
    s_add_u32 s73, s73, s69
    buffer_load_dwordx4 v22, s[44:47], s73 offen offset:0 lds
    buffer_load_dwordx4 v23, s[44:47], s73 offen offset:1024 lds
    s_add_u32 m0, s3, 57344
    s_add_u32 s67, s67, 1
    buffer_load_dwordx4 v22, s[48:51], s73 offen offset:0 lds
    buffer_load_dwordx4 v23, s[48:51], s73 offen offset:1024 lds
    s_cmp_eq_u32 s67, 7
    s_cselect_b32 s67, 0, s67
    s_add_u32 m0, s70, 16384
    s_lshl_b32 s72, s67, 7
    s_add_u32 s72, s72, s68
    buffer_load_dwordx4 v20, s[40:43], s72 offen offset:0 lds
    buffer_load_dwordx4 v21, s[40:43], s72 offen offset:1024 lds
    buffer_load_dwordx4 v108, s[40:43], s72 offen offset:2048 lds
    buffer_load_dwordx4 v109, s[40:43], s72 offen offset:3072 lds
    s_add_u32 m0, s3, 65536
    s_mul_i32 s73, s67, 229376
    s_add_u32 s73, s73, s69
    buffer_load_dwordx4 v22, s[44:47], s73 offen offset:0 lds
    buffer_load_dwordx4 v23, s[44:47], s73 offen offset:1024 lds
    s_add_u32 m0, s3, 73728
    s_add_u32 s67, s67, 1
    buffer_load_dwordx4 v22, s[48:51], s73 offen offset:0 lds
    buffer_load_dwordx4 v23, s[48:51], s73 offen offset:1024 lds
    s_cmp_eq_u32 s67, 7
    s_cselect_b32 s67, 0, s67
    s_mov_b32 s52, s38
    s_and_b32 s53, s39, 0xffff
    s_mov_b32 s54, 268435456
    s_mov_b32 s55, 0x20000
    s_mov_b32 s4, s36
    s_and_b32 s5, s37, 0xffff
    s_mov_b32 s6, 256
    s_mov_b32 s7, 0x20000
    v_and_b32 v4, 31, v1
    v_lshrrev_b32 v0, 5, v1
    v_and_b32 v28, 3, v1
    v_lshrrev_b32 v29, 2, v1
    v_xor_b32 v29, v29, v3
    v_and_b32 v29, 1, v29
    v_or_b32 v29, v29, v28
    v_cmp_eq_u32 vcc, 0, v29
    v_mov_b32 v29, 0x3f803f80
    s_nop 0
    v_cndmask_b32 v24, 0, v29, vcc
    v_cndmask_b32 v25, 0, v29, vcc
    v_cndmask_b32 v26, 0, v29, vcc
    v_cndmask_b32 v27, 0, v29, vcc
    v_bfe_u32 v29, v1, 2, 2
    v_lshlrev_b32 v29, 7, v29
    v_bfe_u32 v30, v1, 3, 1
    v_lshl_add_u32 v29, v30, 6, v29
    v_and_b32 v30, 1, v3
    v_lshl_add_u32 v29, v30, 5, v29
    v_lshl_add_u32 v29, v28, 3, v29
    v_bfe_u32 v30, v1, 1, 3
    v_xor_b32 v30, v30, v0
    v_lshlrev_b32 v30, 4, v30
    v_lshl_add_u32 v30, v4, 7, v30
    s_mul_i32 s71, s63, 4128
    v_xor_b32 v8, s71, v30
    v_xor_b32 v9, 32, v8
    v_xor_b32 v10, 64, v8
    v_xor_b32 v11, 96, v8
    v_lshl_add_u32 v12, v0, 10, v29
    v_xor_b32 v12, s3, v12
    v_add_u32 v12, 98304, v12
    v_xor_b32 v13, 2048, v12
    v_xor_b32 v14, 4096, v12
    v_xor_b32 v15, 6144, v12
    v_xor_b32 v16, 64, v12
    v_xor_b32 v17, 64, v13
    v_xor_b32 v18, 64, v14
    v_xor_b32 v19, 64, v15
    v_mov_b32 v64, 0
    v_mov_b32 v66, 0
    s_lshl_b32 s71, s64, 2
    s_lshr_b32 s66, 0x6543210, s71
    s_and_b32 s66, s66, 7
    s_and_b32 s71, s65, 3
    s_lshl_b32 s71, s71, 1
    s_add_u32 s66, s66, s71
    s_sub_u32 s71, s66, 7
    s_cmp_ge_u32 s66, 7
    s_cselect_b32 s66, s71, s66
    s_mov_b32 s83, s66
    s_mov_b32 s81, s66
    s_mul_i32 s82, s64, 114688
    s_mul_i32 s71, s63, 28672
    s_add_u32 s82, s82, s71
    s_add_u32 s82, s82, 12337152
    s_and_b32 s71, s63, 1
    s_lshl_b32 s71, s71, 10
    v_add_u32 v5, s71, v2
    v_xor_b32 v6, 0x400, v5
    s_mul_i32 s71, s63, 14
    v_and_b32 v7, 15, v1
    v_min_u32 v7, 13, v7
    v_add_u32 v7, s71, v7
    v_and_b32 v28, 3, v7
    v_lshrrev_b32 v7, 2, v7
    v_lshl_add_u32 v7, v7, 3, v28
    v_mul_u32_u24 v7, 7, v7
    v_add_lshl_u32 v7, v7, s64, 7
    s_mov_b32 s12, 13635072
    s_lshl_b32 s71, s63, 8
    s_add_u32 s71, s71, 147456
    v_lshl_add_u32 v90, v4, 3, s71
    s_bfe_u32 s71, s2, 0x10002
    s_lshl_b32 s80, s61, 1
    s_add_u32 s80, s80, s71
    s_lshl_b32 s80, s80, 14
    s_lshl_b32 s71, s63, 9
    s_add_u32 s80, s80, s71
    s_add_u32 s80, s80, 10485760
    s_lshl_b32 s79, s64, 11
    s_add_u32 s79, s79, s80
    v_lshlrev_b32 v68, 4, v4
    v_lshl_add_u32 v69, v0, 11, v68
    v_add_u32 v70, 0x1000, v69
    v_add_u32 v71, 0x2000, v69
    v_add_u32 v91, 0x3000, v68
    s_setprio 0
    s_waitcnt vmcnt(8)
    s_barrier
    ds_read_b128 v[128:131], v8 offset:0
    ds_read_b128 v[132:135], v9 offset:0
    ds_read_b128 v[136:139], v10 offset:0
    ds_read_b128 v[140:143], v11 offset:0
    s_add_u32 m0, s70, 32768
    s_lshl_b32 s72, s67, 7
    s_add_u32 s72, s72, s68
    buffer_load_dwordx4 v20, s[40:43], s72 offen offset:0 lds
    v_mov_b32 v30, 0
    buffer_load_dwordx2 v[30:31], v30, s[4:7], 0 offen sc1
    s_waitcnt lgkmcnt(2)
    v_lshlrev_b32 v28, 16, v128
    v_and_b32 v29, s76, v128
    v_add_f32 v64, v64, v28
    v_fmac_f32 v66, v28, v28
    v_add_f32 v64, v64, v29
    buffer_load_dwordx4 v21, s[40:43], s72 offen offset:1024 lds
    v_fmac_f32 v66, v29, v29
    v_lshlrev_b32 v28, 16, v129
    v_and_b32 v29, s76, v129
    v_add_f32 v64, v64, v28
    v_fmac_f32 v66, v28, v28
    v_add_f32 v64, v64, v29
    buffer_load_dwordx4 v108, s[40:43], s72 offen offset:2048 lds
    v_fmac_f32 v66, v29, v29
    v_lshlrev_b32 v28, 16, v130
    v_and_b32 v29, s76, v130
    v_add_f32 v64, v64, v28
    v_fmac_f32 v66, v28, v28
    v_add_f32 v64, v64, v29
    buffer_load_dwordx4 v109, s[40:43], s72 offen offset:3072 lds
    v_fmac_f32 v66, v29, v29
    v_lshlrev_b32 v28, 16, v131
    v_and_b32 v29, s76, v131
    v_add_f32 v64, v64, v28
    v_fmac_f32 v66, v28, v28
    v_add_f32 v64, v64, v29
    s_add_u32 m0, s3, 81920
    s_mul_i32 s73, s67, 229376
    s_add_u32 s73, s73, s69
    buffer_load_dwordx4 v22, s[44:47], s73 offen offset:0 lds
    v_fmac_f32 v66, v29, v29
    v_lshlrev_b32 v28, 16, v132
    v_and_b32 v29, s76, v132
    v_add_f32 v64, v64, v28
    v_fmac_f32 v66, v28, v28
    v_add_f32 v64, v64, v29
    v_fmac_f32 v66, v29, v29
    buffer_load_dwordx4 v23, s[44:47], s73 offen offset:1024 lds
    v_lshlrev_b32 v28, 16, v133
    v_and_b32 v29, s76, v133
    v_add_f32 v64, v64, v28
    v_fmac_f32 v66, v28, v28
    v_add_f32 v64, v64, v29
    v_fmac_f32 v66, v29, v29
    s_add_u32 m0, s3, 90112
    s_add_u32 s67, s67, 1
    buffer_load_dwordx4 v22, s[48:51], s73 offen offset:0 lds
    v_lshlrev_b32 v28, 16, v134
    v_and_b32 v29, s76, v134
    v_add_f32 v64, v64, v28
    v_fmac_f32 v66, v28, v28
    v_add_f32 v64, v64, v29
    v_fmac_f32 v66, v29, v29
    buffer_load_dwordx4 v23, s[48:51], s73 offen offset:1024 lds
    s_cmp_eq_u32 s67, 7
    s_cselect_b32 s67, 0, s67
    v_lshlrev_b32 v28, 16, v135
    v_and_b32 v29, s76, v135
    v_add_f32 v64, v64, v28
    v_fmac_f32 v66, v28, v28
    v_add_f32 v64, v64, v29
    v_fmac_f32 v66, v29, v29
    s_waitcnt vmcnt(9) lgkmcnt(0)
    s_barrier
    ds_read_b128 v[144:147], v8 offset:16384
    ds_read_b128 v[148:151], v9 offset:16384
    ds_read_b128 v[152:155], v10 offset:16384
    ds_read_b128 v[156:159], v11 offset:16384
    s_add_u32 m0, s70, 0
    s_lshl_b32 s72, s67, 7
    s_add_u32 s72, s72, s68
    buffer_load_dwordx4 v20, s[40:43], s72 offen offset:0 lds
    v_lshlrev_b32 v28, 16, v136
    v_and_b32 v29, s76, v136
    v_add_f32 v64, v64, v28
    v_fmac_f32 v66, v28, v28
    v_add_f32 v64, v64, v29
    v_fmac_f32 v66, v29, v29
    buffer_load_dwordx4 v21, s[40:43], s72 offen offset:1024 lds
    v_lshlrev_b32 v28, 16, v137
    v_and_b32 v29, s76, v137
    v_add_f32 v64, v64, v28
    v_fmac_f32 v66, v28, v28
    v_add_f32 v64, v64, v29
    v_fmac_f32 v66, v29, v29
    buffer_load_dwordx4 v108, s[40:43], s72 offen offset:2048 lds
    v_lshlrev_b32 v28, 16, v138
    v_and_b32 v29, s76, v138
    v_add_f32 v64, v64, v28
    v_fmac_f32 v66, v28, v28
    v_add_f32 v64, v64, v29
    v_fmac_f32 v66, v29, v29
    buffer_load_dwordx4 v109, s[40:43], s72 offen offset:3072 lds
    v_lshlrev_b32 v28, 16, v139
    v_and_b32 v29, s76, v139
    v_add_f32 v64, v64, v28
    v_fmac_f32 v66, v28, v28
    v_add_f32 v64, v64, v29
    v_fmac_f32 v66, v29, v29
    s_add_u32 m0, s3, 49152
    s_mul_i32 s73, s67, 229376
    s_add_u32 s73, s73, s69
    buffer_load_dwordx4 v22, s[44:47], s73 offen offset:0 lds
    v_lshlrev_b32 v28, 16, v140
    v_and_b32 v29, s76, v140
    v_add_f32 v64, v64, v28
    v_fmac_f32 v66, v28, v28
    v_add_f32 v64, v64, v29
    v_fmac_f32 v66, v29, v29
    buffer_load_dwordx4 v23, s[44:47], s73 offen offset:1024 lds
    v_lshlrev_b32 v28, 16, v141
    v_and_b32 v29, s76, v141
    v_add_f32 v64, v64, v28
    v_fmac_f32 v66, v28, v28
    v_add_f32 v64, v64, v29
    v_fmac_f32 v66, v29, v29
    s_add_u32 m0, s3, 57344
    s_add_u32 s67, s67, 1
    buffer_load_dwordx4 v22, s[48:51], s73 offen offset:0 lds
    v_lshlrev_b32 v28, 16, v142
    v_and_b32 v29, s76, v142
    v_add_f32 v64, v64, v28
    v_fmac_f32 v66, v28, v28
    v_add_f32 v64, v64, v29
    v_fmac_f32 v66, v29, v29
    buffer_load_dwordx4 v23, s[48:51], s73 offen offset:1024 lds
    s_cmp_eq_u32 s67, 7
    s_cselect_b32 s67, 0, s67
    v_lshlrev_b32 v28, 16, v143
    v_and_b32 v29, s76, v143
    v_add_f32 v64, v64, v28
    v_fmac_f32 v66, v28, v28
    v_add_f32 v64, v64, v29
    v_fmac_f32 v66, v29, v29
    v_mov_b32 v28, v64
    v_mov_b32 v29, v66
    s_nop 1
    v_permlane32_swap_b32 v28, v64
    v_permlane32_swap_b32 v29, v66
    s_nop 0
    v_add_f32 v64, v28, v64
    v_add_f32 v66, v29, v66
    s_waitcnt vmcnt(15)
    s_mov_b32 s71, 0
kB_nchk:
    v_readfirstlane_b32 s18, v30
    v_readfirstlane_b32 s19, v31
    s_cmp_lg_u64 s[18:19], 0
    s_cbranch_scc1 kB_nok
    buffer_load_dwordx2 v[30:31], v30, s[4:7], 0 offen sc1
    s_add_u32 s71, s71, 1
    s_cmp_gt_u32 s71, 262144
    s_waitcnt vmcnt(0)
    s_cbranch_scc0 kB_nchk
kB_nok:
    s_add_u32 s13, s18, s19
    v_mov_b32 v65, s18
    v_mov_b32 v67, s13
    s_mov_b32 exec_hi, 0
    buffer_store_dwordx4 v[64:67], v68, s[52:55], s79 offen sc0 sc1
    s_mov_b32 exec_hi, -1
    s_waitcnt vmcnt(9) lgkmcnt(0)
    s_barrier
    ds_read_b128 v[160:163], v8 offset:32768
    ds_read_b128 v[164:167], v9 offset:32768
    ds_read_b128 v[168:171], v10 offset:32768
    ds_read_b128 v[172:175], v11 offset:32768
    s_add_u32 m0, s70, 16384
    s_lshl_b32 s72, s67, 7
    s_add_u32 s72, s72, s68
    buffer_load_dwordx4 v20, s[40:43], s72 offen offset:0 lds
    buffer_load_dwordx4 v21, s[40:43], s72 offen offset:1024 lds
    buffer_load_dwordx4 v108, s[40:43], s72 offen offset:2048 lds
    buffer_load_dwordx4 v109, s[40:43], s72 offen offset:3072 lds
    s_add_u32 m0, s3, 65536
    s_mul_i32 s73, s67, 229376
    s_add_u32 s73, s73, s69
    buffer_load_dwordx4 v22, s[44:47], s73 offen offset:0 lds
    buffer_load_dwordx4 v23, s[44:47], s73 offen offset:1024 lds
    s_add_u32 m0, s3, 73728
    s_add_u32 s67, s67, 1
    buffer_load_dwordx4 v22, s[48:51], s73 offen offset:0 lds
    buffer_load_dwordx4 v23, s[48:51], s73 offen offset:1024 lds
    s_cmp_eq_u32 s67, 7
    s_cselect_b32 s67, 0, s67
    s_waitcnt vmcnt(9) lgkmcnt(0)
    s_barrier
    ds_read_b128 v[176:179], v8 offset:0
    ds_read_b128 v[180:183], v9 offset:0
    ds_read_b128 v[184:187], v10 offset:0
    ds_read_b128 v[188:191], v11 offset:0
    s_add_u32 m0, s70, 32768
    s_lshl_b32 s72, s67, 7
    s_add_u32 s72, s72, s68
    buffer_load_dwordx4 v20, s[40:43], s72 offen offset:0 lds
    buffer_load_dwordx4 v21, s[40:43], s72 offen offset:1024 lds
    buffer_load_dwordx4 v108, s[40:43], s72 offen offset:2048 lds
    buffer_load_dwordx4 v109, s[40:43], s72 offen offset:3072 lds
    s_add_u32 m0, s3, 81920
    s_mul_i32 s73, s67, 229376
    s_add_u32 s73, s73, s69
    buffer_load_dwordx4 v22, s[44:47], s73 offen offset:0 lds
    buffer_load_dwordx4 v23, s[44:47], s73 offen offset:1024 lds
    s_add_u32 m0, s3, 90112
    s_add_u32 s67, s67, 1
    buffer_load_dwordx4 v22, s[48:51], s73 offen offset:0 lds
    buffer_load_dwordx4 v23, s[48:51], s73 offen offset:1024 lds
    s_cmp_eq_u32 s67, 7
    s_cselect_b32 s67, 0, s67
    s_waitcnt vmcnt(8) lgkmcnt(0)
    s_barrier
    ds_read_b128 v[192:195], v8 offset:16384
    ds_read_b128 v[196:199], v9 offset:16384
    ds_read_b128 v[200:203], v10 offset:16384
    ds_read_b128 v[204:207], v11 offset:16384
    buffer_load_dwordx4 v[72:75], v69, s[52:55], s80 offen sc1
    buffer_load_dwordx4 v[76:79], v70, s[52:55], s80 offen sc1
    buffer_load_dwordx4 v[80:83], v71, s[52:55], s80 offen sc1
    buffer_load_dwordx4 v[84:87], v91, s[52:55], s80 offen sc1
    s_add_u32 m0, s70, 0
    s_lshl_b32 s72, s67, 7
    s_add_u32 s72, s72, s68
    buffer_load_dwordx4 v20, s[40:43], s72 offen offset:0 lds
    buffer_load_dwordx4 v21, s[40:43], s72 offen offset:1024 lds
    buffer_load_dwordx4 v108, s[40:43], s72 offen offset:2048 lds
    buffer_load_dwordx4 v109, s[40:43], s72 offen offset:3072 lds
    s_add_u32 m0, s3, 49152
    s_mul_i32 s73, s67, 229376
    s_add_u32 s73, s73, s69
    buffer_load_dwordx4 v22, s[44:47], s73 offen offset:0 lds
    buffer_load_dwordx4 v23, s[44:47], s73 offen offset:1024 lds
    s_add_u32 m0, s3, 57344
    s_add_u32 s67, s67, 1
    buffer_load_dwordx4 v22, s[48:51], s73 offen offset:0 lds
    buffer_load_dwordx4 v23, s[48:51], s73 offen offset:1024 lds
    s_cmp_eq_u32 s67, 7
    s_cselect_b32 s67, 0, s67
    s_add_u32 s69, s69, 128
    s_waitcnt vmcnt(12) lgkmcnt(0)
    s_barrier
    ds_read_b128 v[208:211], v8 offset:32768
    ds_read_b128 v[212:215], v9 offset:32768
    ds_read_b128 v[216:219], v10 offset:32768
    ds_read_b128 v[220:223], v11 offset:32768
    s_add_u32 m0, s3, 98304
    s_mul_i32 s73, s67, 229376
    s_add_u32 s73, s73, s69
    buffer_load_dwordx4 v22, s[44:47], s73 offen offset:0 lds
    buffer_load_dwordx4 v23, s[44:47], s73 offen offset:1024 lds
    s_add_u32 m0, s3, 106496
    s_add_u32 s67, s67, 1
    buffer_load_dwordx4 v22, s[48:51], s73 offen offset:0 lds
    buffer_load_dwordx4 v23, s[48:51], s73 offen offset:1024 lds
    s_cmp_eq_u32 s67, 7
    s_cselect_b32 s67, 0, s67
    s_add_u32 m0, s3, 114688
    s_mul_i32 s73, s67, 229376
    s_add_u32 s73, s73, s69
    buffer_load_dwordx4 v22, s[44:47], s73 offen offset:0 lds
    buffer_load_dwordx4 v23, s[44:47], s73 offen offset:1024 lds
    s_add_u32 m0, s3, 122880
    s_add_u32 s67, s67, 1
    buffer_load_dwordx4 v22, s[48:51], s73 offen offset:0 lds
    buffer_load_dwordx4 v23, s[48:51], s73 offen offset:1024 lds
    s_cmp_eq_u32 s67, 7
    s_cselect_b32 s67, 0, s67
    s_waitcnt vmcnt(16)
    s_mov_b32 s71, 0
kB_gchk:
    v_xor_b32 v28, s18, v73
    v_xor_b32 v29, s13, v75
    v_xor_b32 v88, s18, v77
    v_xor_b32 v89, s13, v79
    v_or3_b32 v28, v28, v88, v89
    v_xor_b32 v88, s18, v81
    v_xor_b32 v89, s13, v83
    v_or3_b32 v28, v28, v88, v89
    v_xor_b32 v88, s18, v85
    v_xor_b32 v89, s13, v87
    v_or3_b32 v28, v28, v88, v89
    v_or_b32 v28, v28, v29
    v_cmp_ne_u32 vcc, 0, v28
    s_cbranch_vccz kB_gok
    buffer_load_dwordx4 v[72:75], v69, s[52:55], s80 offen sc1
    buffer_load_dwordx4 v[76:79], v70, s[52:55], s80 offen sc1
    buffer_load_dwordx4 v[80:83], v71, s[52:55], s80 offen sc1
    buffer_load_dwordx4 v[84:87], v91, s[52:55], s80 offen sc1
    s_add_u32 s71, s71, 1
    s_cmp_gt_u32 s71, 262144
    s_waitcnt vmcnt(0)
    s_cbranch_scc0 kB_gchk
kB_gok:
    v_add_f32 v72, v72, v76
    v_add_f32 v72, v72, v80
    v_add_f32 v74, v74, v78
    v_add_f32 v74, v74, v82
    v_mov_b32 v28, v72
    v_mov_b32 v29, v74
    s_nop 1
    v_permlane32_swap_b32 v28, v72
    v_permlane32_swap_b32 v29, v74
    s_nop 0
    v_add_f32 v72, v28, v72
    v_add_f32 v74, v29, v74
    v_add_f32 v64, v72, v84
    v_add_f32 v66, v74, v86
    v_mul_f32 v20, 0xbb124925, v64
    v_mul_f32 v66, 0x3b124925, v66
    v_fma_f32 v66, -v20, v20, v66
    v_max_f32 v66, 0, v66
    v_add_f32 v21, 0x3727c5ac, v66
    ds_write_b64 v90, v[20:21]
    s_waitcnt vmcnt(8) lgkmcnt(1)
    s_barrier
    ds_read_b128 v[224:227], v8 offset:0
    ds_read_b128 v[228:231], v9 offset:0
    ds_read_b128 v[232:235], v10 offset:0
    ds_read_b128 v[236:239], v11 offset:0
    s_add_u32 m0, s3, 131072
    s_mul_i32 s73, s67, 229376
    s_add_u32 s73, s73, s69
    buffer_load_dwordx4 v22, s[44:47], s73 offen offset:0 lds
    buffer_load_dwordx4 v23, s[44:47], s73 offen offset:1024 lds
    s_add_u32 m0, s3, 139264
    s_add_u32 s67, s67, 1
    buffer_load_dwordx4 v22, s[48:51], s73 offen offset:0 lds
    buffer_load_dwordx4 v23, s[48:51], s73 offen offset:1024 lds
    s_cmp_eq_u32 s67, 7
    s_cselect_b32 s67, 0, s67
    s_add_u32 m0, s3, 16384
    s_mul_i32 s73, s67, 229376
    s_add_u32 s73, s73, s69
    buffer_load_dwordx4 v22, s[44:47], s73 offen offset:0 lds
    buffer_load_dwordx4 v23, s[44:47], s73 offen offset:1024 lds
    s_add_u32 m0, s3, 24576
    s_add_u32 s67, s67, 1
    buffer_load_dwordx4 v22, s[48:51], s73 offen offset:0 lds
    buffer_load_dwordx4 v23, s[48:51], s73 offen offset:1024 lds
    s_cmp_eq_u32 s67, 7
    s_cselect_b32 s67, 0, s67
    s_waitcnt vmcnt(8) lgkmcnt(0)
    s_barrier
    s_setprio 3
    ds_read_b64_tr_b16 v[32:33], v12 offset:0
    ds_read_b64_tr_b16 v[34:35], v12 offset:512
    ds_read_b64_tr_b16 v[36:37], v16 offset:0
    ds_read_b64_tr_b16 v[38:39], v16 offset:512
    ds_read_b64_tr_b16 v[40:41], v12 offset:8192
    ds_read_b64_tr_b16 v[42:43], v12 offset:8704
    v_add_u32 v12, 0x4000, v12
    ds_read_b64_tr_b16 v[44:45], v16 offset:8192
    ds_read_b64_tr_b16 v[46:47], v16 offset:8704
    v_add_u32 v16, 0x4000, v16
    ds_read_b64_tr_b16 v[48:49], v13 offset:0
    ds_read_b64_tr_b16 v[50:51], v13 offset:512
    ds_read_b64_tr_b16 v[52:53], v17 offset:0
    ds_read_b64_tr_b16 v[54:55], v17 offset:512
    ds_read_b64_tr_b16 v[56:57], v13 offset:8192
    ds_read_b64_tr_b16 v[58:59], v13 offset:8704
    v_add_u32 v13, 0x4000, v13
    ds_read_b64_tr_b16 v[60:61], v17 offset:8192
    ds_read_b64_tr_b16 v[62:63], v17 offset:8704
    v_add_u32 v17, 0x4000, v17
    s_waitcnt lgkmcnt(14)
    v_mfma_f32_32x32x16_bf16 v[64:79], v[32:35], v[128:131], 0
    v_mfma_f32_16x16x32_bf16 v[240:243], v[24:27], v[32:35], 0
    ds_read_b64_tr_b16 v[32:33], v14 offset:0
    ds_read_b64_tr_b16 v[34:35], v14 offset:512
    s_waitcnt lgkmcnt(14)
    v_mfma_f32_32x32x16_bf16 v[80:95], v[36:39], v[128:131], 0
    ds_read_b64_tr_b16 v[36:37], v18 offset:0
    ds_read_b64_tr_b16 v[38:39], v18 offset:512
    s_waitcnt lgkmcnt(14)
    v_mfma_f32_32x32x16_bf16 v[96:111], v[40:43], v[128:131], 0
    ds_read_b64_tr_b16 v[40:41], v14 offset:8192
    ds_read_b64_tr_b16 v[42:43], v14 offset:8704
    v_add_u32 v14, 0x4000, v14
    s_waitcnt lgkmcnt(14)
    v_mfma_f32_32x32x16_bf16 v[112:127], v[44:47], v[128:131], 0
    ds_read_b64_tr_b16 v[44:45], v18 offset:8192
    ds_read_b64_tr_b16 v[46:47], v18 offset:8704
    v_add_u32 v18, 0x4000, v18
    s_waitcnt lgkmcnt(14)
    v_mfma_f32_32x32x16_bf16 v[64:79], v[48:51], v[132:135], v[64:79]
    ds_read_b64_tr_b16 v[48:49], v15 offset:0
    ds_read_b64_tr_b16 v[50:51], v15 offset:512
    v_cmp_gt_u32 vcc, 32, v1
    s_waitcnt lgkmcnt(14)
    v_mfma_f32_32x32x16_bf16 v[80:95], v[52:55], v[132:135], v[80:95]
    v_mfma_f32_16x16x32_bf16 v[244:247], v[24:27], v[52:55], 0
    ds_read_b64_tr_b16 v[52:53], v19 offset:0
    ds_read_b64_tr_b16 v[54:55], v19 offset:512
    v_mov_b32 v3, 151552
    s_waitcnt lgkmcnt(14)
    v_mfma_f32_32x32x16_bf16 v[96:111], v[56:59], v[132:135], v[96:111]
    ds_read_b64_tr_b16 v[56:57], v15 offset:8192
    ds_read_b64_tr_b16 v[58:59], v15 offset:8704
    v_add_u32 v15, 0x4000, v15
    s_nop 0
    s_waitcnt lgkmcnt(14)
    v_mfma_f32_32x32x16_bf16 v[112:127], v[60:63], v[132:135], v[112:127]
    ds_read_b64_tr_b16 v[60:61], v19 offset:8192
    ds_read_b64_tr_b16 v[62:63], v19 offset:8704
    v_add_u32 v19, 0x4000, v19
    v_cndmask_b32 v20, 0, v20, vcc
    s_waitcnt lgkmcnt(14)
    v_mfma_f32_32x32x16_bf16 v[64:79], v[32:35], v[136:139], v[64:79]
    ds_read_b64_tr_b16 v[32:33], v12 offset:0
    ds_read_b64_tr_b16 v[34:35], v12 offset:512
    v_cvt_pk_bf16_f32 v8, v20, v20
    s_waitcnt lgkmcnt(14)
    v_mfma_f32_32x32x16_bf16 v[80:95], v[36:39], v[136:139], v[80:95]
    ds_read_b64_tr_b16 v[36:37], v16 offset:0
    ds_read_b64_tr_b16 v[38:39], v16 offset:512
    v_lshlrev_b32 v28, 16, v8
    v_sub_f32 v28, v20, v28
    s_waitcnt lgkmcnt(14)
    v_mfma_f32_32x32x16_bf16 v[96:111], v[40:43], v[136:139], v[96:111]
    v_mfma_f32_16x16x32_bf16 v[248:251], v[24:27], v[40:43], 0
    ds_read_b64_tr_b16 v[40:41], v12 offset:8192
    ds_read_b64_tr_b16 v[42:43], v12 offset:8704
    v_add_u32 v12, 0x4000, v12
    v_cvt_pk_bf16_f32 v9, v28, 0
    s_waitcnt lgkmcnt(14)
    v_mfma_f32_32x32x16_bf16 v[112:127], v[44:47], v[136:139], v[112:127]
    ds_read_b64_tr_b16 v[44:45], v16 offset:8192
    ds_read_b64_tr_b16 v[46:47], v16 offset:8704
    v_add_u32 v16, 0x4000, v16
    v_mov_b32 v10, 0
    v_mov_b32 v11, 0
    s_waitcnt lgkmcnt(14)
    v_mfma_f32_32x32x16_bf16 v[64:79], v[48:51], v[140:143], v[64:79]
    ds_read_b64_tr_b16 v[48:49], v13 offset:0
    ds_read_b64_tr_b16 v[50:51], v13 offset:512
    s_waitcnt vmcnt(0)
    s_barrier
    s_mov_b32 s74, 0xc0135761
    s_waitcnt lgkmcnt(14)
    v_mfma_f32_32x32x16_bf16 v[80:95], v[52:55], v[140:143], v[80:95]
    ds_read_b64_tr_b16 v[52:53], v17 offset:0
    ds_read_b64_tr_b16 v[54:55], v17 offset:512
    s_mov_b32 s75, 0xbdd2d3e8
    s_lshl_b32 s71, s61, 2
    s_waitcnt lgkmcnt(14)
    v_mfma_f32_32x32x16_bf16 v[96:111], v[56:59], v[140:143], v[96:111]
    ds_read_b64_tr_b16 v[56:57], v13 offset:8192
    ds_read_b64_tr_b16 v[58:59], v13 offset:8704
    v_add_u32 v13, 0x4000, v13
    s_add_u32 s71, s71, s63
    s_mul_i32 s79, s71, 57344
    s_waitcnt lgkmcnt(14)
    v_mfma_f32_32x32x16_bf16 v[112:127], v[60:63], v[140:143], v[112:127]
    v_mfma_f32_16x16x32_bf16 v[252:255], v[24:27], v[60:63], 0
    ds_read_b64_tr_b16 v[60:61], v17 offset:8192
    ds_read_b64_tr_b16 v[62:63], v17 offset:8704
    v_add_u32 v17, 0x4000, v17
    s_lshl_b32 s71, s62, 12
    s_add_u32 s79, s79, s71
    s_add_u32 s79, s79, 3670016
    s_waitcnt lgkmcnt(14)
    v_mfma_f32_32x32x16_bf16 v[64:79], v[32:35], v[144:147], v[64:79]
    v_mfma_f32_16x16x32_bf16 v[240:243], v[24:27], v[32:35], v[240:243]
    ds_read_b64_tr_b16 v[32:33], v14 offset:0
    ds_read_b64_tr_b16 v[34:35], v14 offset:512
    s_waitcnt lgkmcnt(14)
    v_mfma_f32_32x32x16_bf16 v[80:95], v[36:39], v[144:147], v[80:95]
    ds_read_b64_tr_b16 v[36:37], v18 offset:0
    ds_read_b64_tr_b16 v[38:39], v18 offset:512
    s_waitcnt lgkmcnt(14)
    v_mfma_f32_32x32x16_bf16 v[96:111], v[40:43], v[144:147], v[96:111]
    ds_read_b64_tr_b16 v[40:41], v14 offset:8192
    ds_read_b64_tr_b16 v[42:43], v14 offset:8704
    v_add_u32 v14, 0x4000, v14
    s_waitcnt lgkmcnt(14)
    v_mfma_f32_32x32x16_bf16 v[112:127], v[44:47], v[144:147], v[112:127]
    ds_read_b64_tr_b16 v[44:45], v18 offset:8192
    ds_read_b64_tr_b16 v[46:47], v18 offset:8704
    v_add_u32 v18, 0x4000, v18
    s_waitcnt lgkmcnt(14)
    v_mfma_f32_32x32x16_bf16 v[64:79], v[48:51], v[148:151], v[64:79]
    ds_read_b64_tr_b16 v[48:49], v15 offset:0
    ds_read_b64_tr_b16 v[50:51], v15 offset:512
    buffer_load_dwordx2 v[22:23], v7, s[52:55], s12 offen sc1
    s_waitcnt lgkmcnt(14)
    v_mfma_f32_32x32x16_bf16 v[80:95], v[52:55], v[148:151], v[80:95]
    v_mfma_f32_16x16x32_bf16 v[244:247], v[24:27], v[52:55], v[244:247]
    ds_read_b64_tr_b16 v[52:53], v19 offset:0
    ds_read_b64_tr_b16 v[54:55], v19 offset:512
    s_waitcnt lgkmcnt(14)
    v_mfma_f32_32x32x16_bf16 v[96:111], v[56:59], v[148:151], v[96:111]
    ds_read_b64_tr_b16 v[56:57], v15 offset:8192
    ds_read_b64_tr_b16 v[58:59], v15 offset:8704
    v_add_u32 v15, 0x4000, v15
    s_waitcnt lgkmcnt(14)
    v_mfma_f32_32x32x16_bf16 v[112:127], v[60:63], v[148:151], v[112:127]
    ds_read_b64_tr_b16 v[60:61], v19 offset:8192
    ds_read_b64_tr_b16 v[62:63], v19 offset:8704
    v_add_u32 v19, 0x4000, v19
    s_waitcnt lgkmcnt(14)
    v_mfma_f32_32x32x16_bf16 v[64:79], v[32:35], v[152:155], v[64:79]
    ds_read_b64_tr_b16 v[32:33], v12 offset:0
    ds_read_b64_tr_b16 v[34:35], v12 offset:512
    s_waitcnt lgkmcnt(14)
    v_mfma_f32_32x32x16_bf16 v[80:95], v[36:39], v[152:155], v[80:95]
    ds_read_b64_tr_b16 v[36:37], v16 offset:0
    ds_read_b64_tr_b16 v[38:39], v16 offset:512
    s_waitcnt lgkmcnt(14)
    v_mfma_f32_32x32x16_bf16 v[96:111], v[40:43], v[152:155], v[96:111]
    v_mfma_f32_16x16x32_bf16 v[248:251], v[24:27], v[40:43], v[248:251]
    ds_read_b64_tr_b16 v[40:41], v12 offset:8192
    ds_read_b64_tr_b16 v[42:43], v12 offset:8704
    v_add_u32 v12, 0xfffe4000, v12
    s_waitcnt lgkmcnt(14)
    v_mfma_f32_32x32x16_bf16 v[112:127], v[44:47], v[152:155], v[112:127]
    ds_read_b64_tr_b16 v[44:45], v16 offset:8192
    ds_read_b64_tr_b16 v[46:47], v16 offset:8704
    v_add_u32 v16, 0xfffe4000, v16
    s_waitcnt lgkmcnt(14)
    v_mfma_f32_32x32x16_bf16 v[64:79], v[48:51], v[156:159], v[64:79]
    ds_read_b64_tr_b16 v[48:49], v13 offset:0
    ds_read_b64_tr_b16 v[50:51], v13 offset:512
    s_waitcnt lgkmcnt(14)
    v_mfma_f32_32x32x16_bf16 v[80:95], v[52:55], v[156:159], v[80:95]
    ds_read_b64_tr_b16 v[52:53], v17 offset:0
    ds_read_b64_tr_b16 v[54:55], v17 offset:512
    s_waitcnt lgkmcnt(14)
    v_mfma_f32_32x32x16_bf16 v[96:111], v[56:59], v[156:159], v[96:111]
    ds_read_b64_tr_b16 v[56:57], v13 offset:8192
    ds_read_b64_tr_b16 v[58:59], v13 offset:8704
    v_add_u32 v13, 0xfffe4000, v13
    s_waitcnt lgkmcnt(14)
    v_mfma_f32_32x32x16_bf16 v[112:127], v[60:63], v[156:159], v[112:127]
    v_mfma_f32_16x16x32_bf16 v[252:255], v[24:27], v[60:63], v[252:255]
    ds_read_b64_tr_b16 v[60:61], v17 offset:8192
    ds_read_b64_tr_b16 v[62:63], v17 offset:8704
    v_add_u32 v17, 0xfffe4000, v17
    s_waitcnt lgkmcnt(14)
    v_mfma_f32_32x32x16_bf16 v[64:79], v[32:35], v[160:163], v[64:79]
    v_mfma_f32_16x16x32_bf16 v[240:243], v[24:27], v[32:35], v[240:243]
    ds_read_b64_tr_b16 v[32:33], v14 offset:0
    ds_read_b64_tr_b16 v[34:35], v14 offset:512
    s_waitcnt lgkmcnt(14)
    v_mfma_f32_32x32x16_bf16 v[80:95], v[36:39], v[160:163], v[80:95]
    ds_read_b64_tr_b16 v[36:37], v18 offset:0
    ds_read_b64_tr_b16 v[38:39], v18 offset:512
    s_waitcnt lgkmcnt(14)
    v_mfma_f32_32x32x16_bf16 v[96:111], v[40:43], v[160:163], v[96:111]
    ds_read_b64_tr_b16 v[40:41], v14 offset:8192
    ds_read_b64_tr_b16 v[42:43], v14 offset:8704
    v_add_u32 v14, 0xfffe4000, v14
    s_waitcnt lgkmcnt(14)
    v_mfma_f32_32x32x16_bf16 v[112:127], v[44:47], v[160:163], v[112:127]
    ds_read_b64_tr_b16 v[44:45], v18 offset:8192
    ds_read_b64_tr_b16 v[46:47], v18 offset:8704
    v_add_u32 v18, 0xfffe4000, v18
    s_waitcnt vmcnt(0)
    s_mov_b32 s71, 0
kBw_chk:
    v_cmp_ne_u64 vcc, s[18:19], v[22:23]
    s_cbranch_vccz kBw_ok
    buffer_load_dwordx2 v[22:23], v7, s[52:55], s12 offen sc1
    s_add_u32 s71, s71, 1
    s_cmp_gt_u32 s71, 262144
    s_waitcnt vmcnt(0)
    s_cbranch_scc0 kBw_chk
kBw_ok:
    s_lshl_b32 s72, s83, 12
    s_add_u32 s72, s72, s82
    buffer_load_dwordx4 v[128:131], v5, s[52:55], s72 offen offset:0 sc1
    buffer_load_dwordx4 v[132:135], v6, s[52:55], s72 offen offset:0 sc1
    s_waitcnt lgkmcnt(14)
    v_mfma_f32_32x32x16_bf16 v[64:79], v[48:51], v[164:167], v[64:79]
    ds_read_b64_tr_b16 v[48:49], v15 offset:0
    ds_read_b64_tr_b16 v[50:51], v15 offset:512
    s_waitcnt lgkmcnt(14)
    v_mfma_f32_32x32x16_bf16 v[80:95], v[52:55], v[164:167], v[80:95]
    v_mfma_f32_16x16x32_bf16 v[244:247], v[24:27], v[52:55], v[244:247]
    ds_read_b64_tr_b16 v[52:53], v19 offset:0
    ds_read_b64_tr_b16 v[54:55], v19 offset:512
    s_waitcnt lgkmcnt(14)
    v_mfma_f32_32x32x16_bf16 v[96:111], v[56:59], v[164:167], v[96:111]
    ds_read_b64_tr_b16 v[56:57], v15 offset:8192
    ds_read_b64_tr_b16 v[58:59], v15 offset:8704
    v_add_u32 v15, 0xfffe4000, v15
    s_waitcnt lgkmcnt(14)
    v_mfma_f32_32x32x16_bf16 v[112:127], v[60:63], v[164:167], v[112:127]
    ds_read_b64_tr_b16 v[60:61], v19 offset:8192
    ds_read_b64_tr_b16 v[62:63], v19 offset:8704
    v_add_u32 v19, 0xfffe4000, v19
    buffer_load_dwordx4 v[136:139], v5, s[52:55], s72 offen offset:2048 sc1
    s_waitcnt lgkmcnt(14)
    v_mfma_f32_32x32x16_bf16 v[64:79], v[32:35], v[168:171], v[64:79]
    ds_read_b64_tr_b16 v[32:33], v12 offset:0
    ds_read_b64_tr_b16 v[34:35], v12 offset:512
    s_waitcnt lgkmcnt(14)
    v_mfma_f32_32x32x16_bf16 v[80:95], v[36:39], v[168:171], v[80:95]
    ds_read_b64_tr_b16 v[36:37], v16 offset:0
    ds_read_b64_tr_b16 v[38:39], v16 offset:512
    s_waitcnt lgkmcnt(14)
    v_mfma_f32_32x32x16_bf16 v[96:111], v[40:43], v[168:171], v[96:111]
    v_mfma_f32_16x16x32_bf16 v[248:251], v[24:27], v[40:43], v[248:251]
    ds_read_b64_tr_b16 v[40:41], v12 offset:8192
    ds_read_b64_tr_b16 v[42:43], v12 offset:8704
    v_add_u32 v12, 0xc000, v12
    s_waitcnt lgkmcnt(14)
    v_mfma_f32_32x32x16_bf16 v[112:127], v[44:47], v[168:171], v[112:127]
    ds_read_b64_tr_b16 v[44:45], v16 offset:8192
    ds_read_b64_tr_b16 v[46:47], v16 offset:8704
    v_add_u32 v16, 0xc000, v16
    buffer_load_dwordx4 v[140:143], v6, s[52:55], s72 offen offset:2048 sc1
    s_add_u32 s83, s83, 1
    s_cmp_eq_u32 s83, 7
    s_cselect_b32 s83, 0, s83
    s_waitcnt lgkmcnt(14)
    v_mfma_f32_32x32x16_bf16 v[64:79], v[48:51], v[172:175], v[64:79]
    ds_read_b64_tr_b16 v[48:49], v13 offset:0
    ds_read_b64_tr_b16 v[50:51], v13 offset:512
    s_waitcnt lgkmcnt(14)
    v_mfma_f32_32x32x16_bf16 v[80:95], v[52:55], v[172:175], v[80:95]
    ds_read_b64_tr_b16 v[52:53], v17 offset:0
    ds_read_b64_tr_b16 v[54:55], v17 offset:512
    s_waitcnt lgkmcnt(14)
    v_mfma_f32_32x32x16_bf16 v[96:111], v[56:59], v[172:175], v[96:111]
    ds_read_b64_tr_b16 v[56:57], v13 offset:8192
    ds_read_b64_tr_b16 v[58:59], v13 offset:8704
    v_add_u32 v13, 0xc000, v13
    s_waitcnt lgkmcnt(14)
    v_mfma_f32_32x32x16_bf16 v[112:127], v[60:63], v[172:175], v[112:127]
    v_mfma_f32_16x16x32_bf16 v[252:255], v[24:27], v[60:63], v[252:255]
    ds_read_b64_tr_b16 v[60:61], v17 offset:8192
    ds_read_b64_tr_b16 v[62:63], v17 offset:8704
    v_add_u32 v17, 0xc000, v17
    s_lshl_b32 s72, s83, 12
    s_add_u32 s72, s72, s82
    buffer_load_dwordx4 v[144:147], v5, s[52:55], s72 offen offset:0 sc1
    s_waitcnt lgkmcnt(14)
    v_mfma_f32_32x32x16_bf16 v[64:79], v[32:35], v[176:179], v[64:79]
    v_mfma_f32_16x16x32_bf16 v[240:243], v[24:27], v[32:35], v[240:243]
    ds_read_b64_tr_b16 v[32:33], v14 offset:0
    ds_read_b64_tr_b16 v[34:35], v14 offset:512
    s_waitcnt lgkmcnt(14)
    v_mfma_f32_32x32x16_bf16 v[80:95], v[36:39], v[176:179], v[80:95]
    ds_read_b64_tr_b16 v[36:37], v18 offset:0
    ds_read_b64_tr_b16 v[38:39], v18 offset:512
    s_waitcnt lgkmcnt(14)
    v_mfma_f32_32x32x16_bf16 v[96:111], v[40:43], v[176:179], v[96:111]
    ds_read_b64_tr_b16 v[40:41], v14 offset:8192
    ds_read_b64_tr_b16 v[42:43], v14 offset:8704
    v_add_u32 v14, 0xc000, v14
    s_waitcnt lgkmcnt(14)
    v_mfma_f32_32x32x16_bf16 v[112:127], v[44:47], v[176:179], v[112:127]
    ds_read_b64_tr_b16 v[44:45], v18 offset:8192
    ds_read_b64_tr_b16 v[46:47], v18 offset:8704
    v_add_u32 v18, 0xc000, v18
    buffer_load_dwordx4 v[148:151], v6, s[52:55], s72 offen offset:0 sc1
    s_waitcnt lgkmcnt(14)
    v_mfma_f32_32x32x16_bf16 v[64:79], v[48:51], v[180:183], v[64:79]
    ds_read_b64_tr_b16 v[48:49], v15 offset:0
    ds_read_b64_tr_b16 v[50:51], v15 offset:512
    ds_read_b32 v20, v3
    s_waitcnt lgkmcnt(15)
    v_mfma_f32_32x32x16_bf16 v[80:95], v[52:55], v[180:183], v[80:95]
    v_mfma_f32_16x16x32_bf16 v[244:247], v[24:27], v[52:55], v[244:247]
    ds_read_b64_tr_b16 v[52:53], v19 offset:0
    ds_read_b64_tr_b16 v[54:55], v19 offset:512
    s_waitcnt lgkmcnt(15)
    v_mfma_f32_32x32x16_bf16 v[96:111], v[56:59], v[180:183], v[96:111]
    ds_read_b64_tr_b16 v[56:57], v15 offset:8192
    ds_read_b64_tr_b16 v[58:59], v15 offset:8704
    v_add_u32 v15, 0xc000, v15
    s_waitcnt lgkmcnt(15)
    v_mfma_f32_32x32x16_bf16 v[112:127], v[60:63], v[180:183], v[112:127]
    ds_read_b64_tr_b16 v[60:61], v19 offset:8192
    ds_read_b64_tr_b16 v[62:63], v19 offset:8704
    v_add_u32 v19, 0xc000, v19
    buffer_load_dwordx4 v[152:155], v5, s[52:55], s72 offen offset:2048 sc1
    buffer_load_dwordx4 v[156:159], v6, s[52:55], s72 offen offset:2048 sc1
    s_add_u32 s83, s83, 1
    s_cmp_eq_u32 s83, 7
    s_cselect_b32 s83, 0, s83
    s_waitcnt lgkmcnt(6)
    v_cmp_ne_u32 vcc, 4, v20
    s_cbranch_vccz kB_c
    v_mov_b32 v28, 151552
    s_mov_b32 s71, 0
kBs_sp:
    ds_read_b32 v29, v28
    s_add_u32 s71, s71, 1
    s_cmp_gt_u32 s71, 4194304
    s_waitcnt lgkmcnt(0)
    s_cbranch_scc1 kBs_sok
    v_cmp_ne_u32 vcc, 4, v29
    s_cbranch_vccnz kBs_sp
kBs_sok:
kB_c:
    v_mfma_f32_32x32x16_bf16 v[64:79], v[32:35], v[184:187], v[64:79]
    ds_read_b64_tr_b16 v[32:33], v12 offset:0
    ds_read_b64_tr_b16 v[34:35], v12 offset:512
    v_mfma_f32_32x32x16_bf16 v[80:95], v[36:39], v[184:187], v[80:95]
    ds_read_b64_tr_b16 v[36:37], v16 offset:0
    ds_read_b64_tr_b16 v[38:39], v16 offset:512
    v_mfma_f32_32x32x16_bf16 v[96:111], v[40:43], v[184:187], v[96:111]
    v_mfma_f32_16x16x32_bf16 v[248:251], v[24:27], v[40:43], v[248:251]
    ds_read_b64_tr_b16 v[40:41], v12 offset:8192
    ds_read_b64_tr_b16 v[42:43], v12 offset:8704
    v_add_u32 v12, 0xffff8000, v12
    v_mfma_f32_32x32x16_bf16 v[112:127], v[44:47], v[184:187], v[112:127]
    ds_read_b64_tr_b16 v[44:45], v16 offset:8192
    ds_read_b64_tr_b16 v[46:47], v16 offset:8704
    v_add_u32 v16, 0xffff8000, v16
    s_lshl_b32 s72, s83, 12
    s_add_u32 s72, s72, s82
    buffer_load_dwordx4 v[160:163], v5, s[52:55], s72 offen offset:0 sc1
    v_mfma_f32_32x32x16_bf16 v[64:79], v[48:51], v[188:191], v[64:79]
    ds_read_b64_tr_b16 v[48:49], v13 offset:0
    ds_read_b64_tr_b16 v[50:51], v13 offset:512
    s_waitcnt lgkmcnt(14)
    v_mfma_f32_32x32x16_bf16 v[80:95], v[52:55], v[188:191], v[80:95]
    ds_read_b64_tr_b16 v[52:53], v17 offset:0
    ds_read_b64_tr_b16 v[54:55], v17 offset:512
    s_waitcnt lgkmcnt(14)
    v_mfma_f32_32x32x16_bf16 v[96:111], v[56:59], v[188:191], v[96:111]
    ds_read_b64_tr_b16 v[56:57], v13 offset:8192
    ds_read_b64_tr_b16 v[58:59], v13 offset:8704
    v_add_u32 v13, 0xffff8000, v13
    s_waitcnt lgkmcnt(14)
    v_mfma_f32_32x32x16_bf16 v[112:127], v[60:63], v[188:191], v[112:127]
    v_mfma_f32_16x16x32_bf16 v[252:255], v[24:27], v[60:63], v[252:255]
    ds_read_b64_tr_b16 v[60:61], v17 offset:8192
    ds_read_b64_tr_b16 v[62:63], v17 offset:8704
    v_add_u32 v17, 0xffff8000, v17
    buffer_load_dwordx4 v[164:167], v6, s[52:55], s72 offen offset:0 sc1
    s_waitcnt lgkmcnt(14)
    v_mfma_f32_32x32x16_bf16 v[64:79], v[32:35], v[192:195], v[64:79]
    v_mfma_f32_16x16x32_bf16 v[240:243], v[24:27], v[32:35], v[240:243]
    ds_read_b64_tr_b16 v[32:33], v14 offset:0
    ds_read_b64_tr_b16 v[34:35], v14 offset:512
    s_waitcnt lgkmcnt(14)
    v_mfma_f32_32x32x16_bf16 v[80:95], v[36:39], v[192:195], v[80:95]
    ds_read_b64_tr_b16 v[36:37], v18 offset:0
    ds_read_b64_tr_b16 v[38:39], v18 offset:512
    s_waitcnt lgkmcnt(14)
    v_mfma_f32_32x32x16_bf16 v[96:111], v[40:43], v[192:195], v[96:111]
    ds_read_b64_tr_b16 v[40:41], v14 offset:8192
    ds_read_b64_tr_b16 v[42:43], v14 offset:8704
    v_add_u32 v14, 0xffff8000, v14
    s_waitcnt lgkmcnt(14)
    v_mfma_f32_32x32x16_bf16 v[112:127], v[44:47], v[192:195], v[112:127]
    ds_read_b64_tr_b16 v[44:45], v18 offset:8192
    ds_read_b64_tr_b16 v[46:47], v18 offset:8704
    v_add_u32 v18, 0xffff8000, v18
    buffer_load_dwordx4 v[168:171], v5, s[52:55], s72 offen offset:2048 sc1
    s_waitcnt lgkmcnt(14)
    v_mfma_f32_32x32x16_bf16 v[64:79], v[48:51], v[196:199], v[64:79]
    ds_read_b64_tr_b16 v[48:49], v15 offset:0
    ds_read_b64_tr_b16 v[50:51], v15 offset:512
    s_waitcnt lgkmcnt(14)
    v_mfma_f32_32x32x16_bf16 v[80:95], v[52:55], v[196:199], v[80:95]
    v_mfma_f32_16x16x32_bf16 v[244:247], v[24:27], v[52:55], v[244:247]
    ds_read_b64_tr_b16 v[52:53], v19 offset:0
    ds_read_b64_tr_b16 v[54:55], v19 offset:512
    s_waitcnt lgkmcnt(14)
    v_mfma_f32_32x32x16_bf16 v[96:111], v[56:59], v[196:199], v[96:111]
    ds_read_b64_tr_b16 v[56:57], v15 offset:8192
    ds_read_b64_tr_b16 v[58:59], v15 offset:8704
    v_add_u32 v15, 0xffff8000, v15
    s_waitcnt lgkmcnt(14)
    v_mfma_f32_32x32x16_bf16 v[112:127], v[60:63], v[196:199], v[112:127]
    ds_read_b64_tr_b16 v[60:61], v19 offset:8192
    ds_read_b64_tr_b16 v[62:63], v19 offset:8704
    v_add_u32 v19, 0xffff8000, v19
    buffer_load_dwordx4 v[172:175], v6, s[52:55], s72 offen offset:2048 sc1
    s_add_u32 s83, s83, 1
    s_cmp_eq_u32 s83, 7
    s_cselect_b32 s83, 0, s83
    s_waitcnt lgkmcnt(14)
    v_mfma_f32_32x32x16_bf16 v[64:79], v[32:35], v[200:203], v[64:79]
    ds_read_b64_tr_b16 v[32:33], v12 offset:0
    ds_read_b64_tr_b16 v[34:35], v12 offset:512
    s_waitcnt lgkmcnt(14)
    v_mfma_f32_32x32x16_bf16 v[80:95], v[36:39], v[200:203], v[80:95]
    ds_read_b64_tr_b16 v[36:37], v16 offset:0
    ds_read_b64_tr_b16 v[38:39], v16 offset:512
    s_waitcnt lgkmcnt(14)
    v_mfma_f32_32x32x16_bf16 v[96:111], v[40:43], v[200:203], v[96:111]
    v_mfma_f32_16x16x32_bf16 v[248:251], v[24:27], v[40:43], v[248:251]
    ds_read_b64_tr_b16 v[40:41], v12 offset:8192
    ds_read_b64_tr_b16 v[42:43], v12 offset:8704
    v_add_u32 v12, 0xc000, v12
    s_waitcnt lgkmcnt(14)
    v_mfma_f32_32x32x16_bf16 v[112:127], v[44:47], v[200:203], v[112:127]
    ds_read_b64_tr_b16 v[44:45], v16 offset:8192
    ds_read_b64_tr_b16 v[46:47], v16 offset:8704
    v_add_u32 v16, 0xc000, v16
    s_waitcnt lgkmcnt(14)
    v_mfma_f32_32x32x16_bf16 v[64:79], v[48:51], v[204:207], v[64:79]
    ds_read_b64_tr_b16 v[48:49], v13 offset:0
    ds_read_b64_tr_b16 v[50:51], v13 offset:512
    s_waitcnt lgkmcnt(14)
    v_mfma_f32_32x32x16_bf16 v[80:95], v[52:55], v[204:207], v[80:95]
    ds_read_b64_tr_b16 v[52:53], v17 offset:0
    ds_read_b64_tr_b16 v[54:55], v17 offset:512
    s_waitcnt lgkmcnt(14)
    v_mfma_f32_32x32x16_bf16 v[96:111], v[56:59], v[204:207], v[96:111]
    ds_read_b64_tr_b16 v[56:57], v13 offset:8192
    ds_read_b64_tr_b16 v[58:59], v13 offset:8704
    v_add_u32 v13, 0xc000, v13
    s_waitcnt lgkmcnt(14)
    v_mfma_f32_32x32x16_bf16 v[112:127], v[60:63], v[204:207], v[112:127]
    v_mfma_f32_16x16x32_bf16 v[252:255], v[24:27], v[60:63], v[252:255]
    ds_read_b64_tr_b16 v[60:61], v17 offset:8192
    ds_read_b64_tr_b16 v[62:63], v17 offset:8704
    v_add_u32 v17, 0xc000, v17
    s_waitcnt lgkmcnt(14)
    v_mfma_f32_32x32x16_bf16 v[64:79], v[32:35], v[208:211], v[64:79]
    v_mfma_f32_16x16x32_bf16 v[240:243], v[24:27], v[32:35], v[240:243]
    ds_read_b64_tr_b16 v[32:33], v14 offset:0
    ds_read_b64_tr_b16 v[34:35], v14 offset:512
    s_waitcnt lgkmcnt(14)
    v_mfma_f32_32x32x16_bf16 v[80:95], v[36:39], v[208:211], v[80:95]
    ds_read_b64_tr_b16 v[36:37], v18 offset:0
    ds_read_b64_tr_b16 v[38:39], v18 offset:512
    s_waitcnt lgkmcnt(14)
    v_mfma_f32_32x32x16_bf16 v[96:111], v[40:43], v[208:211], v[96:111]
    ds_read_b64_tr_b16 v[40:41], v14 offset:8192
    ds_read_b64_tr_b16 v[42:43], v14 offset:8704
    v_add_u32 v14, 0xc000, v14
    s_waitcnt lgkmcnt(14)
    v_mfma_f32_32x32x16_bf16 v[112:127], v[44:47], v[208:211], v[112:127]
    ds_read_b64_tr_b16 v[44:45], v18 offset:8192
    ds_read_b64_tr_b16 v[46:47], v18 offset:8704
    v_add_u32 v18, 0xc000, v18
    s_waitcnt lgkmcnt(14)
    v_mfma_f32_32x32x16_bf16 v[64:79], v[48:51], v[212:215], v[64:79]
    ds_read_b64_tr_b16 v[48:49], v15 offset:0
    ds_read_b64_tr_b16 v[50:51], v15 offset:512
    s_waitcnt lgkmcnt(14)
    v_mfma_f32_32x32x16_bf16 v[80:95], v[52:55], v[212:215], v[80:95]
    v_mfma_f32_16x16x32_bf16 v[244:247], v[24:27], v[52:55], v[244:247]
    ds_read_b64_tr_b16 v[52:53], v19 offset:0
    ds_read_b64_tr_b16 v[54:55], v19 offset:512
    s_waitcnt lgkmcnt(14)
    v_mfma_f32_32x32x16_bf16 v[96:111], v[56:59], v[212:215], v[96:111]
    ds_read_b64_tr_b16 v[56:57], v15 offset:8192
    ds_read_b64_tr_b16 v[58:59], v15 offset:8704
    v_add_u32 v15, 0xc000, v15
    s_waitcnt lgkmcnt(14)
    v_mfma_f32_32x32x16_bf16 v[112:127], v[60:63], v[212:215], v[112:127]
    ds_read_b64_tr_b16 v[60:61], v19 offset:8192
    ds_read_b64_tr_b16 v[62:63], v19 offset:8704
    v_add_u32 v19, 0xc000, v19
    s_waitcnt lgkmcnt(14)
    v_mfma_f32_32x32x16_bf16 v[64:79], v[32:35], v[216:219], v[64:79]
    ds_read_b64_tr_b16 v[32:33], v12 offset:0
    ds_read_b64_tr_b16 v[34:35], v12 offset:512
    s_waitcnt lgkmcnt(14)
    v_mfma_f32_32x32x16_bf16 v[80:95], v[36:39], v[216:219], v[80:95]
    ds_read_b64_tr_b16 v[36:37], v16 offset:0
    ds_read_b64_tr_b16 v[38:39], v16 offset:512
    s_waitcnt lgkmcnt(14)
    v_mfma_f32_32x32x16_bf16 v[96:111], v[40:43], v[216:219], v[96:111]
    v_mfma_f32_16x16x32_bf16 v[248:251], v[24:27], v[40:43], v[248:251]
    ds_read_b64_tr_b16 v[40:41], v12 offset:8192
    ds_read_b64_tr_b16 v[42:43], v12 offset:8704
    s_waitcnt lgkmcnt(14)
    v_mfma_f32_32x32x16_bf16 v[112:127], v[44:47], v[216:219], v[112:127]
    ds_read_b64_tr_b16 v[44:45], v16 offset:8192
    ds_read_b64_tr_b16 v[46:47], v16 offset:8704
    s_waitcnt lgkmcnt(14)
    v_mfma_f32_32x32x16_bf16 v[64:79], v[48:51], v[220:223], v[64:79]
    ds_read_b64_tr_b16 v[48:49], v13 offset:0
    ds_read_b64_tr_b16 v[50:51], v13 offset:512
    s_lshl_b32 s71, s63, 2
    s_waitcnt lgkmcnt(14)
    v_mfma_f32_32x32x16_bf16 v[80:95], v[52:55], v[220:223], v[80:95]
    ds_read_b64_tr_b16 v[52:53], v17 offset:0
    ds_read_b64_tr_b16 v[54:55], v17 offset:512
    s_add_u32 s71, s71, 149504
    v_lshl_add_u32 v22, v4, 6, s71
    s_waitcnt lgkmcnt(14)
    v_mfma_f32_32x32x16_bf16 v[96:111], v[56:59], v[220:223], v[96:111]
    ds_read_b64_tr_b16 v[56:57], v13 offset:8192
    ds_read_b64_tr_b16 v[58:59], v13 offset:8704
    v_lshlrev_b32 v23, 6, v4
    s_waitcnt lgkmcnt(14)
    v_mfma_f32_32x32x16_bf16 v[112:127], v[60:63], v[220:223], v[112:127]
    v_mfma_f32_16x16x32_bf16 v[252:255], v[24:27], v[60:63], v[252:255]
    ds_read_b64_tr_b16 v[60:61], v17 offset:8192
    ds_read_b64_tr_b16 v[62:63], v17 offset:8704
    v_add_u32 v23, 149504, v23
    v_mov_b32 v20, v21
    s_waitcnt lgkmcnt(14)
    v_mfma_f32_32x32x16_bf16 v[64:79], v[32:35], v[224:227], v[64:79]
    v_mfma_f32_16x16x32_bf16 v[240:243], v[24:27], v[32:35], v[240:243]
    ds_read_b64_tr_b16 v[32:33], v14 offset:0
    ds_read_b64_tr_b16 v[34:35], v14 offset:512
    s_waitcnt lgkmcnt(14)
    v_mfma_f32_32x32x16_bf16 v[80:95], v[36:39], v[224:227], v[80:95]
    v_mfma_f32_16x16x32_bf16 v[244:247], v[24:27], v[36:39], v[244:247]
    ds_read_b64_tr_b16 v[36:37], v18 offset:0
    ds_read_b64_tr_b16 v[38:39], v18 offset:512
    s_waitcnt lgkmcnt(14)
    v_mfma_f32_32x32x16_bf16 v[96:111], v[40:43], v[224:227], v[96:111]
    v_mfma_f32_16x16x32_bf16 v[248:251], v[24:27], v[40:43], v[248:251]
    ds_read_b64_tr_b16 v[40:41], v14 offset:8192
    ds_read_b64_tr_b16 v[42:43], v14 offset:8704
    s_waitcnt lgkmcnt(14)
    v_mfma_f32_32x32x16_bf16 v[112:127], v[44:47], v[224:227], v[112:127]
    v_mfma_f32_16x16x32_bf16 v[252:255], v[24:27], v[44:47], v[252:255]
    ds_read_b64_tr_b16 v[44:45], v18 offset:8192
    ds_read_b64_tr_b16 v[46:47], v18 offset:8704
    s_waitcnt lgkmcnt(14)
    v_mfma_f32_32x32x16_bf16 v[64:79], v[48:51], v[228:231], v[64:79]
    ds_read_b64_tr_b16 v[48:49], v15 offset:0
    ds_read_b64_tr_b16 v[50:51], v15 offset:512
    s_waitcnt lgkmcnt(14)
    v_mfma_f32_32x32x16_bf16 v[80:95], v[52:55], v[228:231], v[80:95]
    ds_read_b64_tr_b16 v[52:53], v19 offset:0
    ds_read_b64_tr_b16 v[54:55], v19 offset:512
    ds_write2_b32 v22, v240, v244 offset0:0 offset1:4
    s_waitcnt lgkmcnt(15)
    v_mfma_f32_32x32x16_bf16 v[96:111], v[56:59], v[228:231], v[96:111]
    ds_read_b64_tr_b16 v[56:57], v15 offset:8192
    ds_read_b64_tr_b16 v[58:59], v15 offset:8704
    ds_write2_b32 v22, v248, v252 offset0:8 offset1:12
    s_waitcnt lgkmcnt(15)
    v_mfma_f32_32x32x16_bf16 v[112:127], v[60:63], v[228:231], v[112:127]
    ds_read_b64_tr_b16 v[60:61], v19 offset:8192
    ds_read_b64_tr_b16 v[62:63], v19 offset:8704
    v_mov_b32 v28, 151556
    v_mov_b32 v29, 1
    s_mov_b64 exec, 1
    ds_add_u32 v28, v29
    s_mov_b64 exec, -1
    s_waitcnt lgkmcnt(15)
    v_mfma_f32_32x32x16_bf16 v[64:79], v[32:35], v[232:235], v[64:79]
    v_rsq_f32 v17, v20
    s_nop 0
    v_mul_f32 v16, s74, v17
    v_mfma_f32_32x32x16_bf16 v[80:95], v[36:39], v[232:235], v[80:95]
    v_mul_f32 v18, v17, v17
    v_mul_f32 v18, v18, v17
    v_mul_f32 v18, s75, v18
    s_waitcnt lgkmcnt(13)
    v_mfma_f32_32x32x16_bf16 v[96:111], v[40:43], v[232:235], v[96:111]
    s_waitcnt lgkmcnt(11)
    v_mfma_f32_32x32x16_bf16 v[112:127], v[44:47], v[232:235], v[112:127]
    v_mov_b32 v28, 151556
    s_mov_b32 s71, 0
kBd_sp:
    ds_read_b32 v29, v28
    s_add_u32 s71, s71, 1
    s_cmp_gt_u32 s71, 4194304
    s_waitcnt lgkmcnt(0)
    s_cbranch_scc1 kBd_sok
    v_cmp_ne_u32 vcc, 4, v29
    s_cbranch_vccnz kBd_sp
kBd_sok:
    ds_read_b128 v[208:211], v23 offset:0
    ds_read_b128 v[216:219], v23 offset:32
    ds_read_b128 v[212:215], v23 offset:16
    ds_read_b128 v[220:223], v23 offset:48
    v_mfma_f32_32x32x16_bf16 v[64:79], v[48:51], v[236:239], v[64:79]
    v_mfma_f32_32x32x16_bf16 v[80:95], v[52:55], v[236:239], v[80:95]
    v_mfma_f32_32x32x16_bf16 v[96:111], v[56:59], v[236:239], v[96:111]
    s_waitcnt lgkmcnt(3)
    v_add_f32 v208, v208, v209
    v_add_f32 v210, v210, v211
    v_add_f32 v208, v208, v210
    v_cvt_pk_bf16_f32 v241, v208, 0
    v_lshlrev_b32 v28, 16, v241
    v_sub_f32 v28, v208, v28
    v_cvt_pk_bf16_f32 v240, v208, v28
    v_mov_b32 v242, 0
    v_mov_b32 v243, 0
    v_mfma_f32_32x32x16_bf16 v[112:127], v[60:63], v[236:239], v[112:127]
    s_waitcnt lgkmcnt(2)
    v_add_f32 v216, v216, v217
    v_add_f32 v218, v218, v219
    v_add_f32 v216, v216, v218
    v_cvt_pk_bf16_f32 v249, v216, 0
    v_lshlrev_b32 v28, 16, v249
    v_sub_f32 v28, v216, v28
    v_cvt_pk_bf16_f32 v248, v216, v28
    v_mov_b32 v250, 0
    v_mov_b32 v251, 0
    v_mfma_f32_32x32x16_bf16 v[64:79], v[240:243], v[8:11], v[64:79]
    s_nop 0
    v_mfma_f32_32x32x16_bf16 v[96:111], v[248:251], v[8:11], v[96:111]
    s_waitcnt lgkmcnt(1)
    v_add_f32 v212, v212, v213
    v_add_f32 v214, v214, v215
    v_add_f32 v212, v212, v214
    v_cvt_pk_bf16_f32 v245, v212, 0
    v_lshlrev_b32 v28, 16, v245
    v_sub_f32 v28, v212, v28
    v_cvt_pk_bf16_f32 v244, v212, v28
    v_mov_b32 v246, 0
    v_mov_b32 v247, 0
    s_waitcnt lgkmcnt(0)
    v_add_f32 v220, v220, v221
    v_add_f32 v222, v222, v223
    v_add_f32 v220, v220, v222
    v_cvt_pk_bf16_f32 v253, v220, 0
    v_lshlrev_b32 v28, 16, v253
    v_sub_f32 v28, v220, v28
    v_cvt_pk_bf16_f32 v252, v220, v28
    v_mov_b32 v254, 0
    v_mov_b32 v255, 0
    v_mfma_f32_32x32x16_bf16 v[80:95], v[244:247], v[8:11], v[80:95]
    s_nop 0
    v_mfma_f32_32x32x16_bf16 v[112:127], v[252:255], v[8:11], v[112:127]
    v_pk_mul_f32 v[32:33], v[64:65], v[64:65]
    v_pk_mul_f32 v[34:35], v[66:67], v[66:67]
    v_pk_mul_f32 v[36:37], v[68:69], v[68:69]
    v_pk_mul_f32 v[38:39], v[70:71], v[70:71]
    v_pk_fma_f32 v[32:33], v[32:33], v[18:19], v[16:17] op_sel_hi:[1,0,0]
    v_pk_fma_f32 v[34:35], v[34:35], v[18:19], v[16:17] op_sel_hi:[1,0,0]
    v_pk_fma_f32 v[36:37], v[36:37], v[18:19], v[16:17] op_sel_hi:[1,0,0]
    v_pk_fma_f32 v[38:39], v[38:39], v[18:19], v[16:17] op_sel_hi:[1,0,0]
    v_pk_mul_f32 v[32:33], v[32:33], v[64:65]
    v_pk_mul_f32 v[34:35], v[34:35], v[66:67]
    v_pk_mul_f32 v[36:37], v[36:37], v[68:69]
    v_pk_mul_f32 v[38:39], v[38:39], v[70:71]
    v_exp_f32 v32, v32
    v_exp_f32 v33, v33
    v_exp_f32 v34, v34
    v_exp_f32 v35, v35
    v_exp_f32 v36, v36
    v_exp_f32 v37, v37
    v_exp_f32 v38, v38
    v_exp_f32 v39, v39
    v_pk_mul_f32 v[96:97], v[64:65], v[96:97]
    v_pk_mul_f32 v[98:99], v[66:67], v[98:99]
    v_pk_mul_f32 v[100:101], v[68:69], v[100:101]
    v_pk_mul_f32 v[102:103], v[70:71], v[102:103]
    v_pk_fma_f32 v[32:33], v[32:33], v[20:21], v[20:21] op_sel_hi:[1,0,0]
    v_pk_fma_f32 v[34:35], v[34:35], v[20:21], v[20:21] op_sel_hi:[1,0,0]
    v_pk_fma_f32 v[36:37], v[36:37], v[20:21], v[20:21] op_sel_hi:[1,0,0]
    v_pk_fma_f32 v[38:39], v[38:39], v[20:21], v[20:21] op_sel_hi:[1,0,0]
    v_rcp_f32 v32, v32
    v_rcp_f32 v33, v33
    v_rcp_f32 v34, v34
    v_rcp_f32 v35, v35
    v_rcp_f32 v36, v36
    v_rcp_f32 v37, v37
    v_rcp_f32 v38, v38
    v_rcp_f32 v39, v39
    v_pk_mul_f32 v[96:97], v[96:97], v[32:33]
    v_pk_mul_f32 v[98:99], v[98:99], v[34:35]
    v_pk_mul_f32 v[100:101], v[100:101], v[36:37]
    v_pk_mul_f32 v[102:103], v[102:103], v[38:39]
    v_cvt_pk_bf16_f32 v48, v96, v97
    v_cvt_pk_bf16_f32 v49, v98, v99
    v_cvt_pk_bf16_f32 v50, v100, v101
    v_cvt_pk_bf16_f32 v51, v102, v103
    buffer_store_dwordx4 v[48:51], v2, s[52:55], s79 offen offset:0 sc1
    v_pk_mul_f32 v[40:41], v[72:73], v[72:73]
    v_pk_mul_f32 v[42:43], v[74:75], v[74:75]
    v_pk_mul_f32 v[44:45], v[76:77], v[76:77]
    v_pk_mul_f32 v[46:47], v[78:79], v[78:79]
    v_pk_fma_f32 v[40:41], v[40:41], v[18:19], v[16:17] op_sel_hi:[1,0,0]
    v_pk_fma_f32 v[42:43], v[42:43], v[18:19], v[16:17] op_sel_hi:[1,0,0]
    v_pk_fma_f32 v[44:45], v[44:45], v[18:19], v[16:17] op_sel_hi:[1,0,0]
    v_pk_fma_f32 v[46:47], v[46:47], v[18:19], v[16:17] op_sel_hi:[1,0,0]
    v_pk_mul_f32 v[40:41], v[40:41], v[72:73]
    v_pk_mul_f32 v[42:43], v[42:43], v[74:75]
    v_pk_mul_f32 v[44:45], v[44:45], v[76:77]
    v_pk_mul_f32 v[46:47], v[46:47], v[78:79]
    v_exp_f32 v40, v40
    v_exp_f32 v41, v41
    v_exp_f32 v42, v42
    v_exp_f32 v43, v43
    v_exp_f32 v44, v44
    v_exp_f32 v45, v45
    v_exp_f32 v46, v46
    v_exp_f32 v47, v47
    v_pk_mul_f32 v[104:105], v[72:73], v[104:105]
    v_pk_mul_f32 v[106:107], v[74:75], v[106:107]
    v_pk_mul_f32 v[108:109], v[76:77], v[108:109]
    v_pk_mul_f32 v[110:111], v[78:79], v[110:111]
    v_pk_fma_f32 v[40:41], v[40:41], v[20:21], v[20:21] op_sel_hi:[1,0,0]
    v_pk_fma_f32 v[42:43], v[42:43], v[20:21], v[20:21] op_sel_hi:[1,0,0]
    v_pk_fma_f32 v[44:45], v[44:45], v[20:21], v[20:21] op_sel_hi:[1,0,0]
    v_pk_fma_f32 v[46:47], v[46:47], v[20:21], v[20:21] op_sel_hi:[1,0,0]
    v_rcp_f32 v40, v40
    v_rcp_f32 v41, v41
    v_rcp_f32 v42, v42
    v_rcp_f32 v43, v43
    v_rcp_f32 v44, v44
    v_rcp_f32 v45, v45
    v_rcp_f32 v46, v46
    v_rcp_f32 v47, v47
    v_pk_mul_f32 v[104:105], v[104:105], v[40:41]
    v_pk_mul_f32 v[106:107], v[106:107], v[42:43]
    v_pk_mul_f32 v[108:109], v[108:109], v[44:45]
    v_pk_mul_f32 v[110:111], v[110:111], v[46:47]
    v_cvt_pk_bf16_f32 v52, v104, v105
    v_cvt_pk_bf16_f32 v53, v106, v107
    v_cvt_pk_bf16_f32 v54, v108, v109
    v_cvt_pk_bf16_f32 v55, v110, v111
    buffer_store_dwordx4 v[52:55], v2, s[52:55], s79 offen offset:1024 sc1
    v_pk_mul_f32 v[32:33], v[80:81], v[80:81]
    v_pk_mul_f32 v[34:35], v[82:83], v[82:83]
    v_pk_mul_f32 v[36:37], v[84:85], v[84:85]
    v_pk_mul_f32 v[38:39], v[86:87], v[86:87]
    v_pk_fma_f32 v[32:33], v[32:33], v[18:19], v[16:17] op_sel_hi:[1,0,0]
    v_pk_fma_f32 v[34:35], v[34:35], v[18:19], v[16:17] op_sel_hi:[1,0,0]
    v_pk_fma_f32 v[36:37], v[36:37], v[18:19], v[16:17] op_sel_hi:[1,0,0]
    v_pk_fma_f32 v[38:39], v[38:39], v[18:19], v[16:17] op_sel_hi:[1,0,0]
    v_pk_mul_f32 v[32:33], v[32:33], v[80:81]
    v_pk_mul_f32 v[34:35], v[34:35], v[82:83]
    v_pk_mul_f32 v[36:37], v[36:37], v[84:85]
    v_pk_mul_f32 v[38:39], v[38:39], v[86:87]
    v_exp_f32 v32, v32
    v_exp_f32 v33, v33
    v_exp_f32 v34, v34
    v_exp_f32 v35, v35
    v_exp_f32 v36, v36
    v_exp_f32 v37, v37
    v_exp_f32 v38, v38
    v_exp_f32 v39, v39
    v_pk_mul_f32 v[112:113], v[80:81], v[112:113]
    v_pk_mul_f32 v[114:115], v[82:83], v[114:115]
    v_pk_mul_f32 v[116:117], v[84:85], v[116:117]
    v_pk_mul_f32 v[118:119], v[86:87], v[118:119]
    v_pk_fma_f32 v[32:33], v[32:33], v[20:21], v[20:21] op_sel_hi:[1,0,0]
    v_pk_fma_f32 v[34:35], v[34:35], v[20:21], v[20:21] op_sel_hi:[1,0,0]
    v_pk_fma_f32 v[36:37], v[36:37], v[20:21], v[20:21] op_sel_hi:[1,0,0]
    v_pk_fma_f32 v[38:39], v[38:39], v[20:21], v[20:21] op_sel_hi:[1,0,0]
    v_rcp_f32 v32, v32
    v_rcp_f32 v33, v33
    v_rcp_f32 v34, v34
    v_rcp_f32 v35, v35
    v_rcp_f32 v36, v36
    v_rcp_f32 v37, v37
    v_rcp_f32 v38, v38
    v_rcp_f32 v39, v39
    v_pk_mul_f32 v[112:113], v[112:113], v[32:33]
    v_pk_mul_f32 v[114:115], v[114:115], v[34:35]
    v_pk_mul_f32 v[116:117], v[116:117], v[36:37]
    v_pk_mul_f32 v[118:119], v[118:119], v[38:39]
    v_cvt_pk_bf16_f32 v56, v112, v113
    v_cvt_pk_bf16_f32 v57, v114, v115
    v_cvt_pk_bf16_f32 v58, v116, v117
    v_cvt_pk_bf16_f32 v59, v118, v119
    buffer_store_dwordx4 v[56:59], v2, s[52:55], s79 offen offset:2048 sc1
    v_pk_mul_f32 v[40:41], v[88:89], v[88:89]
    v_pk_mul_f32 v[42:43], v[90:91], v[90:91]
    v_pk_mul_f32 v[44:45], v[92:93], v[92:93]
    v_pk_mul_f32 v[46:47], v[94:95], v[94:95]
    v_pk_fma_f32 v[40:41], v[40:41], v[18:19], v[16:17] op_sel_hi:[1,0,0]
    v_pk_fma_f32 v[42:43], v[42:43], v[18:19], v[16:17] op_sel_hi:[1,0,0]
    v_pk_fma_f32 v[44:45], v[44:45], v[18:19], v[16:17] op_sel_hi:[1,0,0]
    v_pk_fma_f32 v[46:47], v[46:47], v[18:19], v[16:17] op_sel_hi:[1,0,0]
    v_pk_mul_f32 v[40:41], v[40:41], v[88:89]
    v_pk_mul_f32 v[42:43], v[42:43], v[90:91]
    v_pk_mul_f32 v[44:45], v[44:45], v[92:93]
    v_pk_mul_f32 v[46:47], v[46:47], v[94:95]
    v_exp_f32 v40, v40
    v_exp_f32 v41, v41
    v_exp_f32 v42, v42
    v_exp_f32 v43, v43
    v_exp_f32 v44, v44
    v_exp_f32 v45, v45
    v_exp_f32 v46, v46
    v_exp_f32 v47, v47
    v_pk_mul_f32 v[120:121], v[88:89], v[120:121]
    v_pk_mul_f32 v[122:123], v[90:91], v[122:123]
    v_pk_mul_f32 v[124:125], v[92:93], v[124:125]
    v_pk_mul_f32 v[126:127], v[94:95], v[126:127]
    v_pk_fma_f32 v[40:41], v[40:41], v[20:21], v[20:21] op_sel_hi:[1,0,0]
    v_pk_fma_f32 v[42:43], v[42:43], v[20:21], v[20:21] op_sel_hi:[1,0,0]
    v_pk_fma_f32 v[44:45], v[44:45], v[20:21], v[20:21] op_sel_hi:[1,0,0]
    v_pk_fma_f32 v[46:47], v[46:47], v[20:21], v[20:21] op_sel_hi:[1,0,0]
    v_rcp_f32 v40, v40
    v_rcp_f32 v41, v41
    v_rcp_f32 v42, v42
    v_rcp_f32 v43, v43
    v_rcp_f32 v44, v44
    v_rcp_f32 v45, v45
    v_rcp_f32 v46, v46
    v_rcp_f32 v47, v47
    v_pk_mul_f32 v[120:121], v[120:121], v[40:41]
    v_pk_mul_f32 v[122:123], v[122:123], v[42:43]
    v_pk_mul_f32 v[124:125], v[124:125], v[44:45]
    v_pk_mul_f32 v[126:127], v[126:127], v[46:47]
    v_cvt_pk_bf16_f32 v60, v120, v121
    v_cvt_pk_bf16_f32 v61, v122, v123
    v_cvt_pk_bf16_f32 v62, v124, v125
    v_cvt_pk_bf16_f32 v63, v126, v127
    buffer_store_dwordx4 v[60:63], v2, s[52:55], s79 offen offset:3072 sc1
    s_lshl_b32 s72, s83, 12
    s_add_u32 s72, s72, s82
    buffer_load_dwordx4 v[176:179], v5, s[52:55], s72 offen offset:0 sc1
    buffer_load_dwordx4 v[180:183], v6, s[52:55], s72 offen offset:0 sc1
    buffer_load_dwordx4 v[184:187], v5, s[52:55], s72 offen offset:2048 sc1
    buffer_load_dwordx4 v[188:191], v6, s[52:55], s72 offen offset:2048 sc1
    s_add_u32 s83, s83, 1
    s_cmp_eq_u32 s83, 7
    s_cselect_b32 s83, 0, s83
    s_lshl_b32 s72, s83, 12
    s_add_u32 s72, s72, s82
    buffer_load_dwordx4 v[192:195], v5, s[52:55], s72 offen offset:0 sc1
    buffer_load_dwordx4 v[196:199], v6, s[52:55], s72 offen offset:0 sc1
    buffer_load_dwordx4 v[200:203], v5, s[52:55], s72 offen offset:2048 sc1
    buffer_load_dwordx4 v[204:207], v6, s[52:55], s72 offen offset:2048 sc1
    s_add_u32 s83, s83, 1
    s_cmp_eq_u32 s83, 7
    s_cselect_b32 s83, 0, s83
    s_waitcnt vmcnt(8)
    s_lshl_b32 s71, s61, 4
    s_add_u32 s71, s71, s62
    s_lshl_b32 s71, s71, 3
    s_add_u32 s71, s71, s60
    s_lshl_b32 s71, s71, 7
    s_add_u32 s71, s71, 9437184
    v_lshlrev_b32 v28, 3, v1
    s_mov_b64 exec, 0xffff
    buffer_store_dwordx2 v[30:31], v28, s[52:55], s71 offen sc0 sc1
    s_mov_b64 exec, -1
    s_setprio 1
    s_lshl_b32 s72, s83, 12
    s_add_u32 s72, s72, s82
    buffer_load_dwordx4 v[208:211], v5, s[52:55], s72 offen offset:0 sc1
    buffer_load_dwordx4 v[212:215], v6, s[52:55], s72 offen offset:0 sc1
    buffer_load_dwordx4 v[216:219], v5, s[52:55], s72 offen offset:2048 sc1
    buffer_load_dwordx4 v[220:223], v6, s[52:55], s72 offen offset:2048 sc1
    s_add_u32 s83, s83, 1
    s_cmp_eq_u32 s83, 7
    s_cselect_b32 s83, 0, s83
    s_lshl_b32 s72, s83, 12
    s_add_u32 s72, s72, s82
    buffer_load_dwordx4 v[224:227], v5, s[52:55], s72 offen offset:0 sc1
    buffer_load_dwordx4 v[228:231], v6, s[52:55], s72 offen offset:0 sc1
    buffer_load_dwordx4 v[232:235], v5, s[52:55], s72 offen offset:2048 sc1
    buffer_load_dwordx4 v[236:239], v6, s[52:55], s72 offen offset:2048 sc1
    s_add_u32 s83, s83, 1
    s_cmp_eq_u32 s83, 7
    s_cselect_b32 s83, 0, s83
    s_lshr_b32 s71, s63, 1
    s_lshl_b32 s71, s71, 5
    s_add_u32 s71, s71, s65
    s_xor_b32 s73, s71, 32
    s_mul_i32 s79, s71, 57344
    s_mul_i32 s80, s73, 57344
    s_mul_i32 s71, s63, 14336
    s_add_u32 s71, s71, 3670016
    s_add_u32 s79, s79, s71
    s_add_u32 s80, s80, s71
    s_mul_i32 s71, s63, 7
    v_and_b32 v8, 7, v1
    v_min_u32 v8, 6, v8
    v_add_u32 v8, s71, v8
    v_lshrrev_b32 v10, 1, v8
    v_bfe_u32 v9, v1, 3, 1
    v_lshl_add_u32 v10, v9, 7, v10
    s_lshr_b32 s73, s65, 2
    s_lshl_b32 s73, s73, 4
    v_add_lshl_u32 v10, v10, s73, 3
    s_and_b32 s71, s65, 3
    s_add_u32 s71, s71, 4
    v_add_lshl_u32 v8, v10, s71, 7
    s_mov_b32 s12, 9437184
    buffer_load_dwordx2 v[16:17], v8, s[52:55], s12 offen sc1
    v_add_u32 v9, s70, v2
    v_add_u32 v9, 0x14000, v9
    v_mul_u32_u24 v3, 57344, v4
    v_lshl_add_u32 v3, v0, 3, v3
    s_lshr_b32 s73, s63, 1
    s_lshl_b32 s73, s73, 5
    s_add_u32 s73, s73, s65
    s_mul_i32 s8, s73, 896
    s_lshl_b32 s71, s64, 7
    s_add_u32 s8, s8, s71
    s_and_b32 s71, s63, 1
    s_lshl_b32 s71, s71, 6
    s_add_u32 s8, s8, s71
    s_mov_b32 s56, s34
    s_and_b32 s57, s35, 0xffff
    s_mov_b32 s58, 1835008
    s_mov_b32 s59, 0x20000
    v_add_u32 v10, s70, v2
    v_xor_b32 v11, 0x3000, v10
    v_xor_b32 v13, 4096, v9
    v_xor_b32 v14, 8192, v9
    v_xor_b32 v15, 12288, v9
    s_mov_b32 s74, 0xbfb8aa3b
    s_mov_b32 s75, 0xbfb8aa3b
    s_waitcnt vmcnt(0)
    s_mov_b32 s71, 0
kBh_chk:
    v_cmp_ne_u64 vcc, s[18:19], v[16:17]
    s_cbranch_vccz kBh_ok
    buffer_load_dwordx2 v[16:17], v8, s[52:55], s12 offen sc1
    s_add_u32 s71, s71, 1
    s_cmp_gt_u32 s71, 262144
    s_waitcnt vmcnt(0)
    s_cbranch_scc0 kBh_chk
kBh_ok:
    s_lshl_b32 s71, s81, 11
    s_add_u32 s72, s71, s79
    s_add_u32 s73, s71, s80
    s_add_u32 s81, s81, 1
    s_cmp_eq_u32 s81, 7
    s_cselect_b32 s81, 0, s81
    buffer_load_dwordx4 v[32:35], v2, s[52:55], s72 offen offset:0 sc1
    buffer_load_dwordx4 v[36:39], v2, s[52:55], s73 offen offset:0 sc1
    buffer_load_dwordx4 v[40:43], v2, s[52:55], s72 offen offset:1024 sc1
    buffer_load_dwordx4 v[44:47], v2, s[52:55], s73 offen offset:1024 sc1
    s_lshl_b32 s71, s81, 11
    s_add_u32 s72, s71, s79
    s_add_u32 s73, s71, s80
    s_add_u32 s81, s81, 1
    s_cmp_eq_u32 s81, 7
    s_cselect_b32 s81, 0, s81
    buffer_load_dwordx4 v[48:51], v2, s[52:55], s72 offen offset:0 sc1
    buffer_load_dwordx4 v[52:55], v2, s[52:55], s73 offen offset:0 sc1
    buffer_load_dwordx4 v[56:59], v2, s[52:55], s72 offen offset:1024 sc1
    buffer_load_dwordx4 v[60:63], v2, s[52:55], s73 offen offset:1024 sc1
    s_lshl_b32 s71, s81, 11
    s_add_u32 s72, s71, s79
    s_add_u32 s73, s71, s80
    s_add_u32 s81, s81, 1
    s_cmp_eq_u32 s81, 7
    s_cselect_b32 s81, 0, s81
    buffer_load_dwordx4 v[240:243], v2, s[52:55], s72 offen offset:0 sc1
    buffer_load_dwordx4 v[244:247], v2, s[52:55], s73 offen offset:0 sc1
    buffer_load_dwordx4 v[248:251], v2, s[52:55], s72 offen offset:1024 sc1
    buffer_load_dwordx4 v[252:255], v2, s[52:55], s73 offen offset:1024 sc1
    s_waitcnt vmcnt(11)
    v_mfma_f32_32x32x16_bf16 v[64:79], v[128:131], v[32:35], 0
    v_mfma_f32_32x32x16_bf16 v[80:95], v[132:135], v[32:35], 0
    s_lshl_b32 s71, s81, 11
    s_add_u32 s72, s71, s79
    s_add_u32 s73, s71, s80
    s_add_u32 s81, s81, 1
    s_cmp_eq_u32 s81, 7
    s_cselect_b32 s81, 0, s81
    buffer_load_dwordx4 v[32:35], v2, s[52:55], s72 offen offset:0 sc1
    s_waitcnt vmcnt(11)
    v_mfma_f32_32x32x16_bf16 v[96:111], v[128:131], v[36:39], 0
    v_mfma_f32_32x32x16_bf16 v[112:127], v[132:135], v[36:39], 0
    buffer_load_dwordx4 v[36:39], v2, s[52:55], s73 offen offset:0 sc1
    buffer_load_dwordx4 v[128:131], v2, s[52:55], s72 offen offset:1024 sc1
    buffer_load_dwordx4 v[132:135], v2, s[52:55], s73 offen offset:1024 sc1
    s_waitcnt vmcnt(13)
    v_mfma_f32_32x32x16_bf16 v[64:79], v[136:139], v[40:43], v[64:79]
    v_mfma_f32_32x32x16_bf16 v[80:95], v[140:143], v[40:43], v[80:95]
    s_lshl_b32 s71, s81, 11
    s_add_u32 s72, s71, s79
    s_add_u32 s73, s71, s80
    s_add_u32 s81, s81, 1
    s_cmp_eq_u32 s81, 7
    s_cselect_b32 s81, 0, s81
    buffer_load_dwordx4 v[40:43], v2, s[52:55], s72 offen offset:0 sc1
    s_waitcnt vmcnt(13)
    v_mfma_f32_32x32x16_bf16 v[96:111], v[136:139], v[44:47], v[96:111]
    v_mfma_f32_32x32x16_bf16 v[112:127], v[140:143], v[44:47], v[112:127]
    buffer_load_dwordx4 v[44:47], v2, s[52:55], s73 offen offset:0 sc1
    buffer_load_dwordx4 v[136:139], v2, s[52:55], s72 offen offset:1024 sc1
    buffer_load_dwordx4 v[140:143], v2, s[52:55], s73 offen offset:1024 sc1
    s_waitcnt vmcnt(15)
    v_mfma_f32_32x32x16_bf16 v[64:79], v[144:147], v[48:51], v[64:79]
    v_mfma_f32_32x32x16_bf16 v[80:95], v[148:151], v[48:51], v[80:95]
    s_lshl_b32 s71, s81, 11
    s_add_u32 s72, s71, s79
    s_add_u32 s73, s71, s80
    s_add_u32 s81, s81, 1
    s_cmp_eq_u32 s81, 7
    s_cselect_b32 s81, 0, s81
    buffer_load_dwordx4 v[48:51], v2, s[52:55], s72 offen offset:0 sc1
    s_waitcnt vmcnt(15)
    v_mfma_f32_32x32x16_bf16 v[96:111], v[144:147], v[52:55], v[96:111]
    v_mfma_f32_32x32x16_bf16 v[112:127], v[148:151], v[52:55], v[112:127]
    buffer_load_dwordx4 v[52:55], v2, s[52:55], s73 offen offset:0 sc1
    buffer_load_dwordx4 v[144:147], v2, s[52:55], s72 offen offset:1024 sc1
    buffer_load_dwordx4 v[148:151], v2, s[52:55], s73 offen offset:1024 sc1
    s_waitcnt vmcnt(17)
    v_mfma_f32_32x32x16_bf16 v[64:79], v[152:155], v[56:59], v[64:79]
    v_mfma_f32_32x32x16_bf16 v[80:95], v[156:159], v[56:59], v[80:95]
    s_lshl_b32 s71, s81, 11
    s_add_u32 s72, s71, s79
    s_add_u32 s73, s71, s80
    s_add_u32 s81, s81, 1
    s_cmp_eq_u32 s81, 7
    s_cselect_b32 s81, 0, s81
    buffer_load_dwordx4 v[56:59], v2, s[52:55], s72 offen offset:0 sc1
    s_waitcnt vmcnt(17)
    v_mfma_f32_32x32x16_bf16 v[96:111], v[152:155], v[60:63], v[96:111]
    v_mfma_f32_32x32x16_bf16 v[112:127], v[156:159], v[60:63], v[112:127]
    buffer_load_dwordx4 v[60:63], v2, s[52:55], s73 offen offset:0 sc1
    buffer_load_dwordx4 v[152:155], v2, s[52:55], s72 offen offset:1024 sc1
    buffer_load_dwordx4 v[156:159], v2, s[52:55], s73 offen offset:1024 sc1
    s_waitcnt vmcnt(19)
    v_mfma_f32_32x32x16_bf16 v[64:79], v[160:163], v[240:243], v[64:79]
    v_mfma_f32_32x32x16_bf16 v[80:95], v[164:167], v[240:243], v[80:95]
    s_waitcnt vmcnt(18)
    v_mfma_f32_32x32x16_bf16 v[96:111], v[160:163], v[244:247], v[96:111]
    v_mfma_f32_32x32x16_bf16 v[112:127], v[164:167], v[244:247], v[112:127]
    s_waitcnt vmcnt(17)
    v_mfma_f32_32x32x16_bf16 v[64:79], v[168:171], v[248:251], v[64:79]
    v_mfma_f32_32x32x16_bf16 v[80:95], v[172:175], v[248:251], v[80:95]
    s_waitcnt vmcnt(16)
    v_mfma_f32_32x32x16_bf16 v[96:111], v[168:171], v[252:255], v[96:111]
    v_mfma_f32_32x32x16_bf16 v[112:127], v[172:175], v[252:255], v[112:127]
    s_waitcnt vmcnt(15)
    v_mfma_f32_32x32x16_bf16 v[64:79], v[176:179], v[32:35], v[64:79]
    v_mfma_f32_32x32x16_bf16 v[80:95], v[180:183], v[32:35], v[80:95]
    s_waitcnt vmcnt(14)
    v_mfma_f32_32x32x16_bf16 v[96:111], v[176:179], v[36:39], v[96:111]
    v_mfma_f32_32x32x16_bf16 v[112:127], v[180:183], v[36:39], v[112:127]
    s_waitcnt vmcnt(13)
    v_mfma_f32_32x32x16_bf16 v[64:79], v[184:187], v[128:131], v[64:79]
    v_mfma_f32_32x32x16_bf16 v[80:95], v[188:191], v[128:131], v[80:95]
    s_waitcnt vmcnt(12)
    v_mfma_f32_32x32x16_bf16 v[96:111], v[184:187], v[132:135], v[96:111]
    v_mfma_f32_32x32x16_bf16 v[112:127], v[188:191], v[132:135], v[112:127]
    s_waitcnt vmcnt(11)
    v_mfma_f32_32x32x16_bf16 v[64:79], v[192:195], v[40:43], v[64:79]
    v_mfma_f32_32x32x16_bf16 v[80:95], v[196:199], v[40:43], v[80:95]
    s_waitcnt vmcnt(10)
    v_mfma_f32_32x32x16_bf16 v[96:111], v[192:195], v[44:47], v[96:111]
    v_mfma_f32_32x32x16_bf16 v[112:127], v[196:199], v[44:47], v[112:127]
    s_waitcnt vmcnt(9)
    v_mfma_f32_32x32x16_bf16 v[64:79], v[200:203], v[136:139], v[64:79]
    v_mfma_f32_32x32x16_bf16 v[80:95], v[204:207], v[136:139], v[80:95]
    s_waitcnt vmcnt(7)
    v_mfma_f32_32x32x16_bf16 v[64:79], v[208:211], v[48:51], v[64:79]
    v_mfma_f32_32x32x16_bf16 v[80:95], v[212:215], v[48:51], v[80:95]
    s_waitcnt vmcnt(5)
    v_mfma_f32_32x32x16_bf16 v[64:79], v[216:219], v[144:147], v[64:79]
    v_mfma_f32_32x32x16_bf16 v[80:95], v[220:223], v[144:147], v[80:95]
    s_waitcnt vmcnt(3)
    v_mfma_f32_32x32x16_bf16 v[64:79], v[224:227], v[56:59], v[64:79]
    v_mfma_f32_32x32x16_bf16 v[80:95], v[228:231], v[56:59], v[80:95]
    s_waitcnt vmcnt(1)
    v_mfma_f32_32x32x16_bf16 v[64:79], v[232:235], v[152:155], v[64:79]
    v_mfma_f32_32x32x16_bf16 v[80:95], v[236:239], v[152:155], v[80:95]
    v_mfma_f32_32x32x16_bf16 v[96:111], v[200:203], v[140:143], v[96:111]
    v_mfma_f32_32x32x16_bf16 v[112:127], v[204:207], v[140:143], v[112:127]
    v_mfma_f32_32x32x16_bf16 v[96:111], v[208:211], v[52:55], v[96:111]
    v_mfma_f32_32x32x16_bf16 v[112:127], v[212:215], v[52:55], v[112:127]
    s_nop 7
    ds_write_b128 v9, v[64:67] offset:0
    ds_write_b128 v9, v[68:71] offset:1024
    v_mfma_f32_32x32x16_bf16 v[96:111], v[216:219], v[148:151], v[96:111]
    v_mfma_f32_32x32x16_bf16 v[112:127], v[220:223], v[148:151], v[112:127]
    ds_write_b128 v9, v[80:83] offset:16384
    v_mfma_f32_32x32x16_bf16 v[96:111], v[224:227], v[60:63], v[96:111]
    v_mfma_f32_32x32x16_bf16 v[112:127], v[228:231], v[60:63], v[112:127]
    ds_write_b128 v9, v[84:87] offset:17408
    ds_write_b128 v9, v[88:91] offset:18432
    ds_write_b128 v9, v[92:95] offset:19456
    s_waitcnt vmcnt(0)
    v_mfma_f32_32x32x16_bf16 v[96:111], v[232:235], v[156:159], v[96:111]
    v_mfma_f32_32x32x16_bf16 v[112:127], v[236:239], v[156:159], v[112:127]
    s_nop 10
    ds_write_b128 v9, v[96:99] offset:32768
    ds_write_b128 v9, v[100:103] offset:33792
    ds_write_b128 v9, v[104:107] offset:34816
    ds_write_b128 v9, v[108:111] offset:35840
    ds_write_b128 v9, v[112:115] offset:49152
    ds_write_b128 v9, v[116:119] offset:50176
    ds_write_b128 v9, v[120:123] offset:51200
    ds_write_b128 v9, v[124:127] offset:52224
    s_waitcnt lgkmcnt(0)
    s_setprio 3
    s_barrier
    ds_read_b128 v[160:163], v10 offset:0
    ds_read_b128 v[164:167], v10 offset:1024
    ds_read_b128 v[168:171], v13 offset:18432
    ds_read_b128 v[172:175], v13 offset:19456
    ds_read_b128 v[176:179], v14 offset:34816
    ds_read_b128 v[180:183], v14 offset:35840
    ds_read_b128 v[184:187], v15 offset:51200
    ds_read_b128 v[188:191], v15 offset:52224
    ds_read_b128 v[192:195], v10 offset:2048
    ds_read_b128 v[196:199], v10 offset:3072
    ds_read_b128 v[32:35], v11 offset:49152
    ds_read_b128 v[36:39], v11 offset:50176
    s_waitcnt lgkmcnt(10)
    v_pk_add_f32 v[72:73], v[72:73], v[160:161]
    v_pk_add_f32 v[74:75], v[74:75], v[162:163]
    v_pk_add_f32 v[76:77], v[76:77], v[164:165]
    v_pk_add_f32 v[78:79], v[78:79], v[166:167]
    s_waitcnt lgkmcnt(8)
    v_pk_add_f32 v[72:73], v[72:73], v[168:169]
    v_pk_add_f32 v[74:75], v[74:75], v[170:171]
    v_pk_add_f32 v[76:77], v[76:77], v[172:173]
    v_pk_add_f32 v[78:79], v[78:79], v[174:175]
    s_waitcnt lgkmcnt(6)
    v_pk_add_f32 v[72:73], v[72:73], v[176:177]
    v_pk_add_f32 v[74:75], v[74:75], v[178:179]
    v_pk_add_f32 v[76:77], v[76:77], v[180:181]
    v_pk_add_f32 v[78:79], v[78:79], v[182:183]
    s_waitcnt lgkmcnt(4)
    v_pk_add_f32 v[72:73], v[72:73], v[184:185]
    v_pk_add_f32 v[74:75], v[74:75], v[186:187]
    v_pk_add_f32 v[76:77], v[76:77], v[188:189]
    v_pk_add_f32 v[78:79], v[78:79], v[190:191]
    s_waitcnt lgkmcnt(0)
    v_pk_mul_f32 v[48:49], v[72:73], s[74:75]
    v_pk_mul_f32 v[50:51], v[74:75], s[74:75]
    v_pk_mul_f32 v[52:53], v[76:77], s[74:75]
    v_pk_mul_f32 v[54:55], v[78:79], s[74:75]
    v_exp_f32 v48, v48
    v_exp_f32 v49, v49
    v_exp_f32 v50, v50
    v_exp_f32 v51, v51
    v_exp_f32 v52, v52
    v_exp_f32 v53, v53
    v_exp_f32 v54, v54
    v_exp_f32 v55, v55
    v_pk_mul_f32 v[72:73], v[72:73], v[192:193]
    v_pk_mul_f32 v[74:75], v[74:75], v[194:195]
    v_pk_mul_f32 v[76:77], v[76:77], v[196:197]
    v_pk_mul_f32 v[78:79], v[78:79], v[198:199]
    v_pk_add_f32 v[48:49], v[48:49], 1.0 op_sel_hi:[1,0]
    v_pk_add_f32 v[50:51], v[50:51], 1.0 op_sel_hi:[1,0]
    v_pk_add_f32 v[52:53], v[52:53], 1.0 op_sel_hi:[1,0]
    v_pk_add_f32 v[54:55], v[54:55], 1.0 op_sel_hi:[1,0]
    v_rcp_f32 v48, v48
    v_rcp_f32 v49, v49
    v_rcp_f32 v50, v50
    v_rcp_f32 v51, v51
    v_rcp_f32 v52, v52
    v_rcp_f32 v53, v53
    v_rcp_f32 v54, v54
    v_rcp_f32 v55, v55
    v_pk_fma_f32 v[72:73], v[72:73], v[48:49], v[32:33]
    v_pk_fma_f32 v[74:75], v[74:75], v[50:51], v[34:35]
    v_cvt_pk_bf16_f32 v16, v72, v73
    v_cvt_pk_bf16_f32 v17, v74, v75
    buffer_store_dwordx2 v[16:17], v3, s[56:59], s8 offen offset:32
    s_nop 0
    v_pk_fma_f32 v[76:77], v[76:77], v[52:53], v[36:37]
    v_pk_fma_f32 v[78:79], v[78:79], v[54:55], v[38:39]
    v_cvt_pk_bf16_f32 v18, v76, v77
    v_cvt_pk_bf16_f32 v19, v78, v79
    buffer_store_dwordx2 v[18:19], v3, s[56:59], s8 offen offset:48
    s_endpgm
kA:
    v_mul_u32_u24 v7, 896, v4
    v_add_u32 v5, v6, v7
    v_add_u32 v6, 6144, v5
    s_lshl_b32 s10, s2, 2
    s_add_u32 s10, s10, s63
    s_min_u32 s74, s10, 783
    s_mul_i32 s71, s74, 9363
    s_lshr_b32 s71, s71, 16
    s_mul_i32 s72, s71, 7
    s_sub_u32 s72, s74, s72
    s_mul_i32 s73, s71, 14336
    s_lshl_b32 s74, s72, 7
    s_add_u32 s73, s73, s74
    s_add_u32 m0, s70, 131072
    s_waitcnt lgkmcnt(0)
    s_mov_b32 s56, s32
    s_and_b32 s57, s33, 0xffff
    s_mov_b32 s58, 1605632
    s_mov_b32 s59, 0x20000
    buffer_load_dwordx4 v5, s[56:59], s73 offen lds
    buffer_load_dwordx4 v6, s[56:59], s73 offen offset:1024 lds
    s_bfe_u32 s73, s71, 0x10002
    s_mul_i32 s73, s73, 7
    s_add_u32 s73, s73, s72
    s_mul_i32 s73, s73, 56
    s_lshr_b32 s72, s71, 3
    s_lshl_b32 s72, s72, 2
    s_add_u32 s73, s73, s72
    s_and_b32 s72, s71, 3
    s_add_u32 s73, s73, s72
    s_cmp_ge_u32 s2, 196
    s_cselect_b32 s73, s10, s73
    s_lshl_b32 s11, s73, 11
    s_add_u32 s11, s11, 11534336
    s_lshl_b32 s10, s10, 7
    s_add_u32 s10, s10, 13631488
    s_mov_b32 s52, s38
    s_and_b32 s53, s39, 0xffff
    s_mov_b32 s54, 268435456
    s_mov_b32 s55, 0x20000
    s_mov_b32 s4, s36
    s_and_b32 s5, s37, 0xffff
    s_mov_b32 s6, 256
    s_mov_b32 s7, 0x20000
    v_and_b32 v4, 31, v1
    v_lshrrev_b32 v0, 5, v1
    v_and_b32 v28, 3, v1
    v_lshrrev_b32 v29, 2, v1
    v_xor_b32 v29, v29, v3
    v_and_b32 v29, 1, v29
    v_or_b32 v29, v29, v28
    v_cmp_eq_u32 vcc, 0, v29
    v_mov_b32 v29, 0x3f803f80
    s_nop 0
    v_cndmask_b32 v24, 0, v29, vcc
    v_cndmask_b32 v25, 0, v29, vcc
    v_cndmask_b32 v26, 0, v29, vcc
    v_cndmask_b32 v27, 0, v29, vcc
    v_bfe_u32 v29, v1, 2, 2
    v_lshlrev_b32 v29, 7, v29
    v_bfe_u32 v30, v1, 3, 1
    v_lshl_add_u32 v29, v30, 6, v29
    v_and_b32 v30, 1, v3
    v_lshl_add_u32 v29, v30, 5, v29
    v_lshl_add_u32 v29, v28, 3, v29
    v_bfe_u32 v30, v1, 1, 3
    v_xor_b32 v30, v30, v0
    v_lshlrev_b32 v30, 4, v30
    v_lshl_add_u32 v30, v4, 7, v30
    s_cmp_gt_u32 s60, 1
    s_cbranch_scc1 kA_sd
    s_cmp_eq_u32 s60, 1
    s_cbranch_scc1 kA_sn
    v_mov_b32 v248, 0
    v_mov_b32 v249, 0
    v_mov_b32 v250, 0
    v_mov_b32 v251, 0
    s_lshl_b32 s71, s61, 4
    s_add_u32 s71, s71, s62
    s_lshl_b32 s71, s71, 10
    s_add_u32 s71, s71, 9437184
    buffer_store_dwordx4 v[248:251], v2, s[52:55], s71 offen sc0 sc1
    s_branch kA_sd
kA_sn:
    s_cmp_lg_u32 s2, 0
    s_cbranch_scc1 kA_sd
    s_or_b32 s98, s98, 1
    v_mov_b32 v248, s98
    v_mov_b32 v249, s99
    v_mov_b32 v250, 0
    s_mov_b64 exec, 1
    buffer_store_dwordx2 v[248:249], v250, s[4:7], 0 offen sc0 sc1
    s_mov_b64 exec, -1
kA_sd:
    s_mov_b32 s40, s16
    s_and_b32 s41, s17, 0xffff
    s_mov_b32 s42, 1835008
    s_mov_b32 s43, 0x20000
    s_mov_b32 s44, s28
    s_and_b32 s45, s29, 0xffff
    s_mov_b32 s46, 1605632
    s_mov_b32 s47, 0x20000
    s_mov_b32 s48, s30
    s_and_b32 s49, s31, 0xffff
    s_mov_b32 s50, 1605632
    s_mov_b32 s51, 0x20000
    s_add_u32 s71, s70, 131072
    v_lshl_add_u32 v16, v0, 9, v29
    v_add_u32 v16, s71, v16
    v_xor_b32 v17, 64, v16
    s_setprio 2
    s_lshr_b32 s77, s63, 1
    s_and_b32 s78, s63, 1
    s_mul_i32 s71, s77, 8256
    v_xor_b32 v8, s71, v30
    v_xor_b32 v9, 32, v8
    v_xor_b32 v10, 64, v8
    v_xor_b32 v11, 96, v8
    s_lshl_b32 s71, s77, 12
    s_lshl_b32 s72, s78, 6
    s_add_u32 s71, s71, s72
    v_lshl_add_u32 v12, v0, 10, v29
    v_xor_b32 v12, s71, v12
    v_add_u32 v12, 49152, v12
    v_xor_b32 v13, 2048, v12
    v_xor_b32 v14, 4096, v12
    v_xor_b32 v15, 6144, v12
    v_mov_b32 v28, 0
    v_lshlrev_b32 v29, 2, v1
    v_add_u32 v29, 151552, v29
    ds_write_b32 v29, v28
    s_add_u32 s67, s67, 1
    s_cmp_eq_u32 s67, 7
    s_cselect_b32 s67, 0, s67
    s_add_u32 s67, s67, 1
    s_cmp_eq_u32 s67, 7
    s_cselect_b32 s67, 0, s67
    s_add_u32 s67, s67, 1
    s_cmp_eq_u32 s67, 7
    s_cselect_b32 s67, 0, s67
    s_add_u32 s67, s67, 1
    s_cmp_eq_u32 s67, 7
    s_cselect_b32 s67, 0, s67
    s_add_u32 s69, s69, 128
    s_lshl_b32 s71, s61, 1
    s_add_u32 s71, s71, s77
    s_mul_i32 s79, s71, 114688
    s_lshl_b32 s71, s62, 1
    s_add_u32 s71, s71, s78
    s_lshl_b32 s71, s71, 11
    s_add_u32 s79, s79, s71
    s_add_u32 s80, s79, 57344
    s_mov_b32 s74, 0xc0135761
    s_mov_b32 s75, 0xbdd2d3e8
    s_lshl_b32 s71, s64, 2
    s_lshr_b32 s66, 0x6543210, s71
    s_and_b32 s66, s66, 7
    s_and_b32 s71, s65, 3
    s_lshl_b32 s71, s71, 1
    s_add_u32 s66, s66, s71
    s_sub_u32 s71, s66, 7
    s_cmp_ge_u32 s66, 7
    s_cselect_b32 s66, s71, s66
    s_mov_b32 s83, s66
    s_mov_b32 s81, s66
    s_mul_i32 s82, s64, 114688
    s_mul_i32 s71, s63, 28672
    s_add_u32 s82, s82, s71
    s_add_u32 s82, s82, 11534336
    s_and_b32 s71, s63, 1
    s_lshl_b32 s71, s71, 10
    v_add_u32 v5, s71, v2
    v_xor_b32 v6, 0x400, v5
    s_mul_i32 s71, s63, 14
    v_and_b32 v18, 15, v1
    v_min_u32 v18, 13, v18
    v_add_u32 v18, s71, v18
    v_and_b32 v19, 3, v18
    v_lshrrev_b32 v18, 2, v18
    v_lshl_add_u32 v18, v18, 3, v19
    v_mul_u32_u24 v18, 7, v18
    v_add_lshl_u32 v18, v18, s64, 7
    s_mov_b32 s12, 13631488
    s_lshl_b32 s71, s78, 9
    s_add_u32 s71, s71, 148480
    v_lshl_add_u32 v20, v4, 4, s71
    s_lshl_b32 s71, s77, 3
    v_add_u32 v19, s71, v20
    s_lshl_b32 s71, s77, 9
    s_add_u32 s71, s71, 147456
    v_lshl_add_u32 v21, v4, 3, s71
    v_mul_u32_u24 v3, 57344, v4
    v_lshl_add_u32 v3, v0, 3, v3
    s_lshl_b32 s73, s77, 5
    s_add_u32 s73, s73, s65
    s_mul_i32 s8, s73, 896
    s_lshl_b32 s9, s64, 1
    s_add_u32 s9, s9, s78
    s_lshl_b32 s71, s9, 6
    s_add_u32 s8, s8, s71
    s_mov_b32 s56, s34
    s_and_b32 s57, s35, 0xffff
    s_mov_b32 s58, 1835008
    s_mov_b32 s59, 0x20000
    v_lshl_add_u32 v32, v4, 6, s73
    v_cvt_f32_u32 v32, v32
    s_mov_b32 s71, 0x3a000000
    s_mov_b32 s72, 0xba000000
    s_cmp_ge_u32 s9, 7
    s_cselect_b32 s71, s71, s72
    v_mul_f32 v32, s71, v32
    v_cvt_f32_u32 v33, v0
    v_mul_f32 v33, 4.0, v33
    v_mul_f32 v33, v33, v32
    s_add_u32 s20, s38, 7340032
    s_addc_u32 s21, s39, 0
    s_and_b32 s21, s21, 0xffff
    s_mov_b32 s22, 1835008
    s_mov_b32 s23, 0x20000
    s_lshl_b32 s71, s9, 5
    s_sub_u32 s71, s71, 224
    v_add_u32 v7, s71, v4
    v_sub_u32 v34, 0, v7
    v_max_i32 v7, v7, v34
    s_sub_u32 s71, 32, s65
    s_and_b32 s71, s71, 31
    s_cmp_ge_u32 s9, 7
    s_cselect_b32 s14, s65, s71
    s_movk_i32 s71, 224
    v_cmp_eq_u32 vcc, s71, v7
    v_lshlrev_b32 v7, 4, v7
    v_mul_u32_u24 v34, 114688, v0
    v_add_u32 v7, v7, v34
    v_mov_b32 v34, 0x40000000
    v_cndmask_b32 v7, v7, v34, vcc
    s_mul_i32 s14, s14, 3584
    v_mov_b32 v254, v32
    v_mov_b32 v255, v33
    v_fmamk_f32 v36, v32, 0x00000000, v33
    v_fmamk_f32 v37, v32, 0x3f800000, v33
    v_cos_f32 v38, v36
    v_cos_f32 v39, v37
    v_sin_f32 v36, v36
    v_sin_f32 v37, v37
    v_cvt_pk_bf16_f32 v208, v38, v39
    v_cvt_pk_bf16_f32 v209, v36, v37
    v_fmamk_f32 v36, v32, 0x40000000, v33
    v_fmamk_f32 v37, v32, 0x40400000, v33
    v_cos_f32 v38, v36
    v_cos_f32 v39, v37
    v_sin_f32 v36, v36
    v_sin_f32 v37, v37
    v_cvt_pk_bf16_f32 v210, v38, v39
    v_cvt_pk_bf16_f32 v211, v36, v37
    v_fmamk_f32 v36, v32, 0x41000000, v33
    v_fmamk_f32 v37, v32, 0x41100000, v33
    v_cos_f32 v38, v36
    v_cos_f32 v39, v37
    v_sin_f32 v36, v36
    v_sin_f32 v37, v37
    v_cvt_pk_bf16_f32 v212, v38, v39
    v_cvt_pk_bf16_f32 v213, v36, v37
    v_fmamk_f32 v36, v32, 0x41200000, v33
    v_fmamk_f32 v37, v32, 0x41300000, v33
    v_cos_f32 v38, v36
    v_cos_f32 v39, v37
    v_sin_f32 v36, v36
    v_sin_f32 v37, v37
    v_cvt_pk_bf16_f32 v214, v38, v39
    v_cvt_pk_bf16_f32 v215, v36, v37
    v_fmamk_f32 v36, v32, 0x41800000, v33
    v_fmamk_f32 v37, v32, 0x41880000, v33
    v_cos_f32 v38, v36
    v_cos_f32 v39, v37
    v_sin_f32 v36, v36
    v_sin_f32 v37, v37
    v_cvt_pk_bf16_f32 v216, v38, v39
    v_cvt_pk_bf16_f32 v217, v36, v37
    v_fmamk_f32 v36, v32, 0x41900000, v33
    v_fmamk_f32 v37, v32, 0x41980000, v33
    v_cos_f32 v38, v36
    v_cos_f32 v39, v37
    v_sin_f32 v36, v36
    v_sin_f32 v37, v37
    v_cvt_pk_bf16_f32 v218, v38, v39
    v_cvt_pk_bf16_f32 v219, v36, v37
    v_fmamk_f32 v36, v32, 0x41c00000, v33
    v_fmamk_f32 v37, v32, 0x41c80000, v33
    v_cos_f32 v38, v36
    v_cos_f32 v39, v37
    v_sin_f32 v36, v36
    v_sin_f32 v37, v37
    v_cvt_pk_bf16_f32 v220, v38, v39
    v_cvt_pk_bf16_f32 v221, v36, v37
    v_fmamk_f32 v36, v32, 0x41d00000, v33
    v_fmamk_f32 v37, v32, 0x41d80000, v33
    v_cos_f32 v38, v36
    v_cos_f32 v39, v37
    v_sin_f32 v36, v36
    v_sin_f32 v37, v37
    v_cvt_pk_bf16_f32 v222, v38, v39
    v_cvt_pk_bf16_f32 v223, v36, v37
    v_fmamk_f32 v36, v32, 0x42000000, v33
    v_fmamk_f32 v37, v32, 0x42040000, v33
    v_cos_f32 v38, v36
    v_cos_f32 v39, v37
    v_sin_f32 v36, v36
    v_sin_f32 v37, v37
    v_cvt_pk_bf16_f32 v224, v38, v39
    v_cvt_pk_bf16_f32 v225, v36, v37
    v_fmamk_f32 v36, v32, 0x42080000, v33
    v_fmamk_f32 v37, v32, 0x420c0000, v33
    v_cos_f32 v38, v36
    v_cos_f32 v39, v37
    v_sin_f32 v36, v36
    v_sin_f32 v37, v37
    v_cvt_pk_bf16_f32 v226, v38, v39
    v_cvt_pk_bf16_f32 v227, v36, v37
    v_fmamk_f32 v36, v32, 0x42200000, v33
    v_fmamk_f32 v37, v32, 0x42240000, v33
    v_cos_f32 v38, v36
    v_cos_f32 v39, v37
    v_sin_f32 v36, v36
    v_sin_f32 v37, v37
    v_cvt_pk_bf16_f32 v228, v38, v39
    v_cvt_pk_bf16_f32 v229, v36, v37
    v_fmamk_f32 v36, v32, 0x42280000, v33
    v_fmamk_f32 v37, v32, 0x422c0000, v33
    v_cos_f32 v38, v36
    v_cos_f32 v39, v37
    v_sin_f32 v36, v36
    v_sin_f32 v37, v37
    v_cvt_pk_bf16_f32 v230, v38, v39
    v_cvt_pk_bf16_f32 v231, v36, v37
    v_fmamk_f32 v36, v32, 0x42400000, v33
    v_fmamk_f32 v37, v32, 0x42440000, v33
    v_cos_f32 v38, v36
    v_cos_f32 v39, v37
    v_sin_f32 v36, v36
    v_sin_f32 v37, v37
    v_cvt_pk_bf16_f32 v232, v38, v39
    v_cvt_pk_bf16_f32 v233, v36, v37
    v_fmamk_f32 v36, v32, 0x42480000, v33
    v_fmamk_f32 v37, v32, 0x424c0000, v33
    v_cos_f32 v38, v36
    v_cos_f32 v39, v37
    v_sin_f32 v36, v36
    v_sin_f32 v37, v37
    v_cvt_pk_bf16_f32 v234, v38, v39
    v_cvt_pk_bf16_f32 v235, v36, v37
    v_fmamk_f32 v36, v32, 0x42600000, v33
    v_fmamk_f32 v37, v32, 0x42640000, v33
    v_cos_f32 v38, v36
    v_cos_f32 v39, v37
    v_sin_f32 v36, v36
    v_sin_f32 v37, v37
    v_cvt_pk_bf16_f32 v236, v38, v39
    v_cvt_pk_bf16_f32 v237, v36, v37
    v_fmamk_f32 v36, v32, 0x42680000, v33
    v_fmamk_f32 v37, v32, 0x426c0000, v33
    v_cos_f32 v38, v36
    v_cos_f32 v39, v37
    v_sin_f32 v36, v36
    v_sin_f32 v37, v37
    v_cvt_pk_bf16_f32 v238, v38, v39
    v_cvt_pk_bf16_f32 v239, v36, v37
    s_waitcnt lgkmcnt(0)
    s_barrier
    ds_read_b128 v[32:35], v8 offset:0
    ds_read_b64_tr_b16 v[40:41], v12 offset:0
    ds_read_b64_tr_b16 v[42:43], v12 offset:512
    ds_read_b64_tr_b16 v[44:45], v12 offset:8192
    ds_read_b64_tr_b16 v[46:47], v12 offset:8704
    ds_read_b128 v[36:39], v8 offset:4096
    ds_read_b128 v[48:51], v9 offset:0
    ds_read_b64_tr_b16 v[56:57], v13 offset:0
    ds_read_b64_tr_b16 v[58:59], v13 offset:512
    ds_read_b64_tr_b16 v[60:61], v13 offset:8192
    ds_read_b64_tr_b16 v[62:63], v13 offset:8704
    ds_read_b128 v[52:55], v9 offset:4096
    s_waitcnt lgkmcnt(9)
    v_mfma_f32_32x32x16_bf16 v[64:79], v[40:43], v[32:35], 0
    v_mfma_f32_16x16x32_bf16 v[240:243], v[24:27], v[40:43], 0
    s_waitcnt lgkmcnt(7)
    v_mfma_f32_32x32x16_bf16 v[80:95], v[44:47], v[32:35], 0
    ds_read_b128 v[32:35], v10 offset:0
    s_waitcnt lgkmcnt(7)
    v_mfma_f32_32x32x16_bf16 v[96:111], v[40:43], v[36:39], 0
    ds_read_b64_tr_b16 v[40:41], v14 offset:0
    ds_read_b64_tr_b16 v[42:43], v14 offset:512
    v_mfma_f32_32x32x16_bf16 v[112:127], v[44:47], v[36:39], 0
    ds_read_b64_tr_b16 v[44:45], v14 offset:8192
    ds_read_b64_tr_b16 v[46:47], v14 offset:8704
    ds_read_b128 v[36:39], v10 offset:4096
    s_waitcnt lgkmcnt(9)
    v_mfma_f32_32x32x16_bf16 v[64:79], v[56:59], v[48:51], v[64:79]
    v_mfma_f32_16x16x32_bf16 v[240:243], v[24:27], v[56:59], v[240:243]
    s_waitcnt lgkmcnt(7)
    v_mfma_f32_32x32x16_bf16 v[80:95], v[60:63], v[48:51], v[80:95]
    ds_read_b128 v[48:51], v11 offset:0
    s_waitcnt lgkmcnt(7)
    v_mfma_f32_32x32x16_bf16 v[96:111], v[56:59], v[52:55], v[96:111]
    ds_read_b64_tr_b16 v[56:57], v15 offset:0
    ds_read_b64_tr_b16 v[58:59], v15 offset:512
    v_mfma_f32_32x32x16_bf16 v[112:127], v[60:63], v[52:55], v[112:127]
    ds_read_b64_tr_b16 v[60:61], v15 offset:8192
    ds_read_b64_tr_b16 v[62:63], v15 offset:8704
    ds_read_b128 v[52:55], v11 offset:4096
    s_waitcnt lgkmcnt(9)
    v_mfma_f32_32x32x16_bf16 v[64:79], v[40:43], v[32:35], v[64:79]
    s_waitcnt lgkmcnt(7)
    v_mfma_f32_32x32x16_bf16 v[80:95], v[44:47], v[32:35], v[80:95]
    v_mfma_f32_16x16x32_bf16 v[244:247], v[24:27], v[44:47], 0
    s_waitcnt lgkmcnt(0)
    s_barrier
    ds_read_b128 v[32:35], v8 offset:16384
    v_mfma_f32_32x32x16_bf16 v[96:111], v[40:43], v[36:39], v[96:111]
    ds_read_b64_tr_b16 v[40:41], v12 offset:16384
    ds_read_b64_tr_b16 v[42:43], v12 offset:16896
    v_mfma_f32_32x32x16_bf16 v[112:127], v[44:47], v[36:39], v[112:127]
    ds_read_b64_tr_b16 v[44:45], v12 offset:24576
    ds_read_b64_tr_b16 v[46:47], v12 offset:25088
    ds_read_b128 v[36:39], v8 offset:20480
    v_mfma_f32_32x32x16_bf16 v[64:79], v[56:59], v[48:51], v[64:79]
    v_mfma_f32_32x32x16_bf16 v[80:95], v[60:63], v[48:51], v[80:95]
    v_mfma_f32_16x16x32_bf16 v[244:247], v[24:27], v[60:63], v[244:247]
    ds_read_b128 v[48:51], v9 offset:16384
    v_mfma_f32_32x32x16_bf16 v[96:111], v[56:59], v[52:55], v[96:111]
    ds_read_b64_tr_b16 v[56:57], v13 offset:16384
    ds_read_b64_tr_b16 v[58:59], v13 offset:16896
    v_mfma_f32_32x32x16_bf16 v[112:127], v[60:63], v[52:55], v[112:127]
    ds_read_b64_tr_b16 v[60:61], v13 offset:24576
    ds_read_b64_tr_b16 v[62:63], v13 offset:25088
    ds_read_b128 v[52:55], v9 offset:20480
    s_waitcnt lgkmcnt(9)
    v_mfma_f32_32x32x16_bf16 v[64:79], v[40:43], v[32:35], v[64:79]
    v_mfma_f32_16x16x32_bf16 v[240:243], v[24:27], v[40:43], v[240:243]
    s_waitcnt lgkmcnt(7)
    v_mfma_f32_32x32x16_bf16 v[80:95], v[44:47], v[32:35], v[80:95]
    ds_read_b128 v[32:35], v10 offset:16384
    s_waitcnt lgkmcnt(7)
    v_mfma_f32_32x32x16_bf16 v[96:111], v[40:43], v[36:39], v[96:111]
    ds_read_b64_tr_b16 v[40:41], v14 offset:16384
    ds_read_b64_tr_b16 v[42:43], v14 offset:16896
    v_mfma_f32_32x32x16_bf16 v[112:127], v[44:47], v[36:39], v[112:127]
    ds_read_b64_tr_b16 v[44:45], v14 offset:24576
    ds_read_b64_tr_b16 v[46:47], v14 offset:25088
    ds_read_b128 v[36:39], v10 offset:20480
    s_waitcnt lgkmcnt(9)
    v_mfma_f32_32x32x16_bf16 v[64:79], v[56:59], v[48:51], v[64:79]
    v_mfma_f32_16x16x32_bf16 v[240:243], v[24:27], v[56:59], v[240:243]
    s_waitcnt vmcnt(0)
    ds_read_b64_tr_b16 v[128:129], v16 offset:0
    ds_read_b64_tr_b16 v[130:131], v16 offset:1024
    ds_read_b64_tr_b16 v[132:133], v17 offset:0
    ds_read_b64_tr_b16 v[134:135], v17 offset:1024
    s_waitcnt lgkmcnt(11)
    v_mfma_f32_32x32x16_bf16 v[80:95], v[60:63], v[48:51], v[80:95]
    ds_read_b128 v[48:51], v11 offset:16384
    s_waitcnt lgkmcnt(11)
    v_mfma_f32_32x32x16_bf16 v[96:111], v[56:59], v[52:55], v[96:111]
    ds_read_b64_tr_b16 v[56:57], v15 offset:16384
    ds_read_b64_tr_b16 v[58:59], v15 offset:16896
    v_mfma_f32_32x32x16_bf16 v[112:127], v[60:63], v[52:55], v[112:127]
    ds_read_b64_tr_b16 v[60:61], v15 offset:24576
    ds_read_b64_tr_b16 v[62:63], v15 offset:25088
    ds_read_b128 v[52:55], v11 offset:20480
    s_waitcnt lgkmcnt(13)
    v_mfma_f32_32x32x16_bf16 v[64:79], v[40:43], v[32:35], v[64:79]
    s_waitcnt lgkmcnt(11)
    v_mfma_f32_32x32x16_bf16 v[80:95], v[44:47], v[32:35], v[80:95]
    v_mfma_f32_16x16x32_bf16 v[244:247], v[24:27], v[44:47], v[244:247]
    s_waitcnt lgkmcnt(0)
    s_barrier
    ds_read_b128 v[32:35], v8 offset:32768
    v_mfma_f32_32x32x16_bf16 v[96:111], v[40:43], v[36:39], v[96:111]
    ds_read_b64_tr_b16 v[40:41], v12 offset:32768
    ds_read_b64_tr_b16 v[42:43], v12 offset:33280
    v_mfma_f32_32x32x16_bf16 v[112:127], v[44:47], v[36:39], v[112:127]
    ds_read_b64_tr_b16 v[44:45], v12 offset:40960
    ds_read_b64_tr_b16 v[46:47], v12 offset:41472
    ds_read_b128 v[36:39], v8 offset:36864
    v_mfma_f32_32x32x16_bf16 v[64:79], v[56:59], v[48:51], v[64:79]
    buffer_store_dwordx4 v[128:131], v2, s[52:55], s11 offen sc1
    v_mfma_f32_32x32x16_bf16 v[80:95], v[60:63], v[48:51], v[80:95]
    v_mfma_f32_16x16x32_bf16 v[244:247], v[24:27], v[60:63], v[244:247]
    ds_read_b128 v[48:51], v9 offset:32768
    v_mfma_f32_32x32x16_bf16 v[96:111], v[56:59], v[52:55], v[96:111]
    ds_read_b64_tr_b16 v[56:57], v13 offset:32768
    ds_read_b64_tr_b16 v[58:59], v13 offset:33280
    v_mfma_f32_32x32x16_bf16 v[112:127], v[60:63], v[52:55], v[112:127]
    ds_read_b64_tr_b16 v[60:61], v13 offset:40960
    ds_read_b64_tr_b16 v[62:63], v13 offset:41472
    ds_read_b128 v[52:55], v9 offset:36864
    s_waitcnt lgkmcnt(9)
    v_mfma_f32_32x32x16_bf16 v[64:79], v[40:43], v[32:35], v[64:79]
    v_mfma_f32_16x16x32_bf16 v[240:243], v[24:27], v[40:43], v[240:243]
    buffer_store_dwordx4 v[132:135], v2, s[52:55], s11 offen offset:1024 sc1
    s_waitcnt lgkmcnt(7)
    v_mfma_f32_32x32x16_bf16 v[80:95], v[44:47], v[32:35], v[80:95]
    ds_read_b128 v[32:35], v10 offset:32768
    s_waitcnt lgkmcnt(7)
    v_mfma_f32_32x32x16_bf16 v[96:111], v[40:43], v[36:39], v[96:111]
    ds_read_b64_tr_b16 v[40:41], v14 offset:32768
    ds_read_b64_tr_b16 v[42:43], v14 offset:33280
    v_mfma_f32_32x32x16_bf16 v[112:127], v[44:47], v[36:39], v[112:127]
    ds_read_b64_tr_b16 v[44:45], v14 offset:40960
    ds_read_b64_tr_b16 v[46:47], v14 offset:41472
    ds_read_b128 v[36:39], v10 offset:36864
    s_waitcnt lgkmcnt(9)
    v_mfma_f32_32x32x16_bf16 v[64:79], v[56:59], v[48:51], v[64:79]
    v_mfma_f32_16x16x32_bf16 v[240:243], v[24:27], v[56:59], v[240:243]
    v_mov_b32 v30, 0
    buffer_load_dwordx2 v[30:31], v30, s[4:7], 0 offen sc1
    s_waitcnt lgkmcnt(7)
    v_mfma_f32_32x32x16_bf16 v[80:95], v[60:63], v[48:51], v[80:95]
    ds_read_b128 v[48:51], v11 offset:32768
    s_waitcnt lgkmcnt(7)
    v_mfma_f32_32x32x16_bf16 v[96:111], v[56:59], v[52:55], v[96:111]
    ds_read_b64_tr_b16 v[56:57], v15 offset:32768
    ds_read_b64_tr_b16 v[58:59], v15 offset:33280
    v_mfma_f32_32x32x16_bf16 v[112:127], v[60:63], v[52:55], v[112:127]
    ds_read_b64_tr_b16 v[60:61], v15 offset:40960
    ds_read_b64_tr_b16 v[62:63], v15 offset:41472
    ds_read_b128 v[52:55], v11 offset:36864
    s_waitcnt lgkmcnt(9)
    v_mfma_f32_32x32x16_bf16 v[64:79], v[40:43], v[32:35], v[64:79]
    s_waitcnt lgkmcnt(7)
    v_mfma_f32_32x32x16_bf16 v[80:95], v[44:47], v[32:35], v[80:95]
    v_mfma_f32_16x16x32_bf16 v[244:247], v[24:27], v[44:47], v[244:247]
    s_waitcnt lgkmcnt(0)
    s_barrier
    ds_read_b128 v[32:35], v8 offset:0
    v_mfma_f32_32x32x16_bf16 v[96:111], v[40:43], v[36:39], v[96:111]
    ds_read_b64_tr_b16 v[40:41], v12 offset:0
    ds_read_b64_tr_b16 v[42:43], v12 offset:512
    v_mfma_f32_32x32x16_bf16 v[112:127], v[44:47], v[36:39], v[112:127]
    ds_read_b64_tr_b16 v[44:45], v12 offset:8192
    ds_read_b64_tr_b16 v[46:47], v12 offset:8704
    ds_read_b128 v[36:39], v8 offset:4096
    v_mfma_f32_32x32x16_bf16 v[64:79], v[56:59], v[48:51], v[64:79]
    v_mfma_f32_32x32x16_bf16 v[80:95], v[60:63], v[48:51], v[80:95]
    v_mfma_f32_16x16x32_bf16 v[244:247], v[24:27], v[60:63], v[244:247]
    ds_read_b128 v[48:51], v9 offset:0
    v_mfma_f32_32x32x16_bf16 v[96:111], v[56:59], v[52:55], v[96:111]
    ds_read_b64_tr_b16 v[56:57], v13 offset:0
    ds_read_b64_tr_b16 v[58:59], v13 offset:512
    v_mfma_f32_32x32x16_bf16 v[112:127], v[60:63], v[52:55], v[112:127]
    ds_read_b64_tr_b16 v[60:61], v13 offset:8192
    ds_read_b64_tr_b16 v[62:63], v13 offset:8704
    ds_read_b128 v[52:55], v9 offset:4096
    s_waitcnt lgkmcnt(9)
    v_mfma_f32_32x32x16_bf16 v[64:79], v[40:43], v[32:35], v[64:79]
    v_mfma_f32_16x16x32_bf16 v[240:243], v[24:27], v[40:43], v[240:243]
    s_waitcnt lgkmcnt(7)
    v_mfma_f32_32x32x16_bf16 v[80:95], v[44:47], v[32:35], v[80:95]
    ds_read_b128 v[32:35], v10 offset:0
    s_waitcnt lgkmcnt(7)
    v_mfma_f32_32x32x16_bf16 v[96:111], v[40:43], v[36:39], v[96:111]
    ds_read_b64_tr_b16 v[40:41], v14 offset:0
    ds_read_b64_tr_b16 v[42:43], v14 offset:512
    v_mfma_f32_32x32x16_bf16 v[112:127], v[44:47], v[36:39], v[112:127]
    ds_read_b64_tr_b16 v[44:45], v14 offset:8192
    ds_read_b64_tr_b16 v[46:47], v14 offset:8704
    ds_read_b128 v[36:39], v10 offset:4096
    s_waitcnt lgkmcnt(9)
    v_mfma_f32_32x32x16_bf16 v[64:79], v[56:59], v[48:51], v[64:79]
    v_mfma_f32_16x16x32_bf16 v[240:243], v[24:27], v[56:59], v[240:243]
    s_waitcnt lgkmcnt(7)
    v_mfma_f32_32x32x16_bf16 v[80:95], v[60:63], v[48:51], v[80:95]
    ds_read_b128 v[48:51], v11 offset:0
    s_waitcnt lgkmcnt(7)
    v_mfma_f32_32x32x16_bf16 v[96:111], v[56:59], v[52:55], v[96:111]
    ds_read_b64_tr_b16 v[56:57], v15 offset:0
    ds_read_b64_tr_b16 v[58:59], v15 offset:512
    v_mfma_f32_32x32x16_bf16 v[112:127], v[60:63], v[52:55], v[112:127]
    ds_read_b64_tr_b16 v[60:61], v15 offset:8192
    ds_read_b64_tr_b16 v[62:63], v15 offset:8704
    ds_read_b128 v[52:55], v11 offset:4096
    s_waitcnt lgkmcnt(9)
    v_mfma_f32_32x32x16_bf16 v[64:79], v[40:43], v[32:35], v[64:79]
    s_waitcnt lgkmcnt(7)
    v_mfma_f32_32x32x16_bf16 v[80:95], v[44:47], v[32:35], v[80:95]
    v_mfma_f32_16x16x32_bf16 v[244:247], v[24:27], v[44:47], v[244:247]
    s_waitcnt lgkmcnt(0)
    s_barrier
    ds_read_b128 v[32:35], v8 offset:16384
    v_mfma_f32_32x32x16_bf16 v[96:111], v[40:43], v[36:39], v[96:111]
    ds_read_b64_tr_b16 v[40:41], v12 offset:16384
    ds_read_b64_tr_b16 v[42:43], v12 offset:16896
    v_mfma_f32_32x32x16_bf16 v[112:127], v[44:47], v[36:39], v[112:127]
    ds_read_b64_tr_b16 v[44:45], v12 offset:24576
    ds_read_b64_tr_b16 v[46:47], v12 offset:25088
    ds_read_b128 v[36:39], v8 offset:20480
    v_mfma_f32_32x32x16_bf16 v[64:79], v[56:59], v[48:51], v[64:79]
    v_mfma_f32_32x32x16_bf16 v[80:95], v[60:63], v[48:51], v[80:95]
    v_mfma_f32_16x16x32_bf16 v[244:247], v[24:27], v[60:63], v[244:247]
    ds_read_b128 v[48:51], v9 offset:16384
    s_waitcnt vmcnt(0)
    s_mov_b32 s71, 0
kA_nchk:
    v_readfirstlane_b32 s18, v30
    v_readfirstlane_b32 s19, v31
    s_cmp_lg_u64 s[18:19], 0
    s_cbranch_scc1 kA_nok
    buffer_load_dwordx2 v[30:31], v30, s[4:7], 0 offen sc1
    s_add_u32 s71, s71, 1
    s_cmp_gt_u32 s71, 262144
    s_waitcnt vmcnt(0)
    s_cbranch_scc0 kA_nchk
kA_nok:
    v_lshlrev_b32 v28, 3, v1
    s_mov_b64 exec, 0xffff
    buffer_store_dwordx2 v[30:31], v28, s[52:55], s10 offen sc0 sc1
    s_mov_b64 exec, -1
    v_mfma_f32_32x32x16_bf16 v[96:111], v[56:59], v[52:55], v[96:111]
    ds_read_b64_tr_b16 v[56:57], v13 offset:16384
    ds_read_b64_tr_b16 v[58:59], v13 offset:16896
    v_mfma_f32_32x32x16_bf16 v[112:127], v[60:63], v[52:55], v[112:127]
    ds_read_b64_tr_b16 v[60:61], v13 offset:24576
    ds_read_b64_tr_b16 v[62:63], v13 offset:25088
    ds_read_b128 v[52:55], v9 offset:20480
    s_waitcnt lgkmcnt(9)
    v_mfma_f32_32x32x16_bf16 v[64:79], v[40:43], v[32:35], v[64:79]
    v_mfma_f32_16x16x32_bf16 v[240:243], v[24:27], v[40:43], v[240:243]
    s_waitcnt lgkmcnt(7)
    v_mfma_f32_32x32x16_bf16 v[80:95], v[44:47], v[32:35], v[80:95]
    ds_read_b128 v[32:35], v10 offset:16384
    s_waitcnt lgkmcnt(7)
    v_mfma_f32_32x32x16_bf16 v[96:111], v[40:43], v[36:39], v[96:111]
    ds_read_b64_tr_b16 v[40:41], v14 offset:16384
    ds_read_b64_tr_b16 v[42:43], v14 offset:16896
    v_mfma_f32_32x32x16_bf16 v[112:127], v[44:47], v[36:39], v[112:127]
    ds_read_b64_tr_b16 v[44:45], v14 offset:24576
    ds_read_b64_tr_b16 v[46:47], v14 offset:25088
    ds_read_b128 v[36:39], v10 offset:20480
    s_waitcnt lgkmcnt(9)
    v_mfma_f32_32x32x16_bf16 v[64:79], v[56:59], v[48:51], v[64:79]
    v_mfma_f32_16x16x32_bf16 v[240:243], v[24:27], v[56:59], v[240:243]
    s_waitcnt lgkmcnt(7)
    v_mfma_f32_32x32x16_bf16 v[80:95], v[60:63], v[48:51], v[80:95]
    ds_read_b128 v[48:51], v11 offset:16384
    s_waitcnt lgkmcnt(7)
    v_mfma_f32_32x32x16_bf16 v[96:111], v[56:59], v[52:55], v[96:111]
    ds_read_b64_tr_b16 v[56:57], v15 offset:16384
    ds_read_b64_tr_b16 v[58:59], v15 offset:16896
    v_mfma_f32_32x32x16_bf16 v[112:127], v[60:63], v[52:55], v[112:127]
    ds_read_b64_tr_b16 v[60:61], v15 offset:24576
    ds_read_b64_tr_b16 v[62:63], v15 offset:25088
    ds_read_b128 v[52:55], v11 offset:20480
    s_waitcnt lgkmcnt(9)
    v_mfma_f32_32x32x16_bf16 v[64:79], v[40:43], v[32:35], v[64:79]
    s_waitcnt lgkmcnt(7)
    v_mfma_f32_32x32x16_bf16 v[80:95], v[44:47], v[32:35], v[80:95]
    v_mfma_f32_16x16x32_bf16 v[244:247], v[24:27], v[44:47], v[244:247]
    s_waitcnt lgkmcnt(0)
    s_barrier
    ds_read_b128 v[32:35], v8 offset:32768
    v_mfma_f32_32x32x16_bf16 v[96:111], v[40:43], v[36:39], v[96:111]
    ds_read_b64_tr_b16 v[40:41], v12 offset:32768
    ds_read_b64_tr_b16 v[42:43], v12 offset:33280
    v_mfma_f32_32x32x16_bf16 v[112:127], v[44:47], v[36:39], v[112:127]
    ds_read_b64_tr_b16 v[44:45], v12 offset:40960
    ds_read_b64_tr_b16 v[46:47], v12 offset:41472
    ds_read_b128 v[36:39], v8 offset:36864
    v_mfma_f32_32x32x16_bf16 v[64:79], v[56:59], v[48:51], v[64:79]
    v_mfma_f32_32x32x16_bf16 v[80:95], v[60:63], v[48:51], v[80:95]
    v_mfma_f32_16x16x32_bf16 v[244:247], v[24:27], v[60:63], v[244:247]
    ds_read_b128 v[48:51], v9 offset:32768
    v_mfma_f32_32x32x16_bf16 v[96:111], v[56:59], v[52:55], v[96:111]
    ds_read_b64_tr_b16 v[56:57], v13 offset:32768
    ds_read_b64_tr_b16 v[58:59], v13 offset:33280
    v_mfma_f32_32x32x16_bf16 v[112:127], v[60:63], v[52:55], v[112:127]
    ds_read_b64_tr_b16 v[60:61], v13 offset:40960
    ds_read_b64_tr_b16 v[62:63], v13 offset:41472
    ds_read_b128 v[52:55], v9 offset:36864
    s_waitcnt lgkmcnt(9)
    v_mfma_f32_32x32x16_bf16 v[64:79], v[40:43], v[32:35], v[64:79]
    v_mfma_f32_16x16x32_bf16 v[240:243], v[24:27], v[40:43], v[240:243]
    s_waitcnt lgkmcnt(7)
    v_mfma_f32_32x32x16_bf16 v[80:95], v[44:47], v[32:35], v[80:95]
    ds_read_b128 v[32:35], v10 offset:32768
    s_waitcnt lgkmcnt(7)
    v_mfma_f32_32x32x16_bf16 v[96:111], v[40:43], v[36:39], v[96:111]
    ds_read_b64_tr_b16 v[40:41], v14 offset:32768
    ds_read_b64_tr_b16 v[42:43], v14 offset:33280
    v_mfma_f32_32x32x16_bf16 v[112:127], v[44:47], v[36:39], v[112:127]
    ds_read_b64_tr_b16 v[44:45], v14 offset:40960
    ds_read_b64_tr_b16 v[46:47], v14 offset:41472
    ds_read_b128 v[36:39], v10 offset:36864
    s_waitcnt lgkmcnt(9)
    v_mfma_f32_32x32x16_bf16 v[64:79], v[56:59], v[48:51], v[64:79]
    v_mfma_f32_16x16x32_bf16 v[240:243], v[24:27], v[56:59], v[240:243]
    s_waitcnt lgkmcnt(7)
    v_mfma_f32_32x32x16_bf16 v[80:95], v[60:63], v[48:51], v[80:95]
    ds_read_b128 v[48:51], v11 offset:32768
    s_waitcnt lgkmcnt(7)
    v_mfma_f32_32x32x16_bf16 v[96:111], v[56:59], v[52:55], v[96:111]
    ds_read_b64_tr_b16 v[56:57], v15 offset:32768
    ds_read_b64_tr_b16 v[58:59], v15 offset:33280
    v_mfma_f32_32x32x16_bf16 v[112:127], v[60:63], v[52:55], v[112:127]
    ds_read_b64_tr_b16 v[60:61], v15 offset:40960
    ds_read_b64_tr_b16 v[62:63], v15 offset:41472
    ds_read_b128 v[52:55], v11 offset:36864
    s_waitcnt lgkmcnt(9)
    v_mfma_f32_32x32x16_bf16 v[64:79], v[40:43], v[32:35], v[64:79]
    s_waitcnt lgkmcnt(7)
    v_mfma_f32_32x32x16_bf16 v[80:95], v[44:47], v[32:35], v[80:95]
    v_mfma_f32_16x16x32_bf16 v[244:247], v[24:27], v[44:47], v[244:247]
    s_waitcnt lgkmcnt(0)
    s_barrier
    ds_read_b128 v[32:35], v8 offset:0
    v_mfma_f32_32x32x16_bf16 v[96:111], v[40:43], v[36:39], v[96:111]
    ds_read_b64_tr_b16 v[40:41], v12 offset:0
    ds_read_b64_tr_b16 v[42:43], v12 offset:512
    v_mfma_f32_32x32x16_bf16 v[112:127], v[44:47], v[36:39], v[112:127]
    ds_read_b64_tr_b16 v[44:45], v12 offset:8192
    ds_read_b64_tr_b16 v[46:47], v12 offset:8704
    ds_read_b128 v[36:39], v8 offset:4096
    v_mfma_f32_32x32x16_bf16 v[64:79], v[56:59], v[48:51], v[64:79]
    v_mfma_f32_32x32x16_bf16 v[80:95], v[60:63], v[48:51], v[80:95]
    v_mfma_f32_16x16x32_bf16 v[244:247], v[24:27], v[60:63], v[244:247]
    ds_read_b128 v[48:51], v9 offset:0
    v_mfma_f32_32x32x16_bf16 v[96:111], v[56:59], v[52:55], v[96:111]
    ds_read_b64_tr_b16 v[56:57], v13 offset:0
    ds_read_b64_tr_b16 v[58:59], v13 offset:512
    v_mfma_f32_32x32x16_bf16 v[112:127], v[60:63], v[52:55], v[112:127]
    ds_read_b64_tr_b16 v[60:61], v13 offset:8192
    ds_read_b64_tr_b16 v[62:63], v13 offset:8704
    ds_read_b128 v[52:55], v9 offset:4096
    s_waitcnt lgkmcnt(9)
    v_mfma_f32_32x32x16_bf16 v[64:79], v[40:43], v[32:35], v[64:79]
    v_mfma_f32_16x16x32_bf16 v[240:243], v[24:27], v[40:43], v[240:243]
    s_waitcnt lgkmcnt(7)
    v_mfma_f32_32x32x16_bf16 v[80:95], v[44:47], v[32:35], v[80:95]
    v_mfma_f32_16x16x32_bf16 v[244:247], v[24:27], v[44:47], v[244:247]
    ds_read_b128 v[32:35], v10 offset:0
    s_waitcnt lgkmcnt(7)
    v_mfma_f32_32x32x16_bf16 v[96:111], v[40:43], v[36:39], v[96:111]
    ds_read_b64_tr_b16 v[40:41], v14 offset:0
    ds_read_b64_tr_b16 v[42:43], v14 offset:512
    v_mfma_f32_32x32x16_bf16 v[112:127], v[44:47], v[36:39], v[112:127]
    ds_read_b64_tr_b16 v[44:45], v14 offset:8192
    ds_read_b64_tr_b16 v[46:47], v14 offset:8704
    ds_read_b128 v[36:39], v10 offset:4096
    s_waitcnt lgkmcnt(9)
    v_mfma_f32_32x32x16_bf16 v[64:79], v[56:59], v[48:51], v[64:79]
    v_mfma_f32_16x16x32_bf16 v[240:243], v[24:27], v[56:59], v[240:243]
    s_waitcnt lgkmcnt(7)
    v_mfma_f32_32x32x16_bf16 v[80:95], v[60:63], v[48:51], v[80:95]
    v_mfma_f32_16x16x32_bf16 v[244:247], v[24:27], v[60:63], v[244:247]
    ds_read_b128 v[48:51], v11 offset:0
    s_waitcnt lgkmcnt(7)
    v_mfma_f32_32x32x16_bf16 v[96:111], v[56:59], v[52:55], v[96:111]
    ds_read_b64_tr_b16 v[56:57], v15 offset:0
    ds_read_b64_tr_b16 v[58:59], v15 offset:512
    v_mfma_f32_32x32x16_bf16 v[112:127], v[60:63], v[52:55], v[112:127]
    ds_read_b64_tr_b16 v[60:61], v15 offset:8192
    ds_read_b64_tr_b16 v[62:63], v15 offset:8704
    ds_read_b128 v[52:55], v11 offset:4096
    s_waitcnt lgkmcnt(9)
    v_mfma_f32_32x32x16_bf16 v[64:79], v[40:43], v[32:35], v[64:79]
    ds_write2_b32 v19, v240, v244 offset0:0 offset1:1
    s_waitcnt lgkmcnt(8)
    v_mfma_f32_32x32x16_bf16 v[80:95], v[44:47], v[32:35], v[80:95]
    s_waitcnt lgkmcnt(7)
    v_mfma_f32_32x32x16_bf16 v[96:111], v[40:43], v[36:39], v[96:111]
    v_mfma_f32_32x32x16_bf16 v[112:127], v[44:47], v[36:39], v[112:127]
    s_waitcnt lgkmcnt(1)
    s_barrier
    v_mfma_f32_32x32x16_bf16 v[64:79], v[56:59], v[48:51], v[64:79]
    v_mfma_f32_32x32x16_bf16 v[80:95], v[60:63], v[48:51], v[80:95]
    v_mfma_f32_32x32x16_bf16 v[96:111], v[56:59], v[52:55], v[96:111]
    v_mfma_f32_32x32x16_bf16 v[112:127], v[60:63], v[52:55], v[112:127]
    s_setprio 0
    s_add_u32 m0, s3, 65536
    s_mul_i32 s73, s67, 229376
    s_add_u32 s73, s73, s69
    buffer_load_dwordx4 v22, s[44:47], s73 offen offset:0 lds
    buffer_load_dwordx4 v23, s[44:47], s73 offen offset:1024 lds
    s_add_u32 m0, s3, 73728
    s_add_u32 s67, s67, 1
    buffer_load_dwordx4 v22, s[48:51], s73 offen offset:0 lds
    buffer_load_dwordx4 v23, s[48:51], s73 offen offset:1024 lds
    s_cmp_eq_u32 s67, 7
    s_cselect_b32 s67, 0, s67
    s_add_u32 m0, s3, 32768
    s_mul_i32 s73, s67, 229376
    s_add_u32 s73, s73, s69
    buffer_load_dwordx4 v22, s[44:47], s73 offen offset:0 lds
    buffer_load_dwordx4 v23, s[44:47], s73 offen offset:1024 lds
    s_add_u32 m0, s3, 40960
    s_add_u32 s67, s67, 1
    buffer_load_dwordx4 v22, s[48:51], s73 offen offset:0 lds
    buffer_load_dwordx4 v23, s[48:51], s73 offen offset:1024 lds
    s_cmp_eq_u32 s67, 7
    s_cselect_b32 s67, 0, s67
    v_cmp_gt_u32 vcc, 32, v1
    s_waitcnt lgkmcnt(0)
    s_barrier
    ds_read_b128 v[32:35], v20
    ds_read_b64 v[36:37], v21
    ds_read_b64 v[38:39], v21 offset:256
    s_add_u32 m0, s3, 81920
    s_mul_i32 s73, s67, 229376
    s_add_u32 s73, s73, s69
    buffer_load_dwordx4 v22, s[44:47], s73 offen offset:0 lds
    buffer_load_dwordx4 v23, s[44:47], s73 offen offset:1024 lds
    s_add_u32 m0, s3, 90112
    s_add_u32 s67, s67, 1
    buffer_load_dwordx4 v22, s[48:51], s73 offen offset:0 lds
    buffer_load_dwordx4 v23, s[48:51], s73 offen offset:1024 lds
    s_cmp_eq_u32 s67, 7
    s_cselect_b32 s67, 0, s67
    s_waitcnt lgkmcnt(0)
    v_add_f32 v32, v32, v34
    v_add_f32 v33, v33, v35
    v_cndmask_b32 v36, 0, v36, vcc
    v_cndmask_b32 v38, 0, v38, vcc
    v_cvt_pk_bf16_f32 v40, v36, v36
    v_lshlrev_b32 v34, 16, v40
    v_sub_f32 v34, v36, v34
    v_cvt_pk_bf16_f32 v41, v34, 0
    v_mov_b32 v42, 0
    v_mov_b32 v43, 0
    v_cvt_pk_bf16_f32 v44, v38, v38
    v_lshlrev_b32 v34, 16, v44
    v_sub_f32 v34, v38, v34
    v_cvt_pk_bf16_f32 v45, v34, 0
    v_mov_b32 v46, 0
    v_mov_b32 v47, 0
    v_cvt_pk_bf16_f32 v9, v32, 0
    v_lshlrev_b32 v34, 16, v9
    v_sub_f32 v34, v32, v34
    v_cvt_pk_bf16_f32 v8, v32, v34
    v_mov_b32 v10, 0
    v_mov_b32 v11, 0
    v_cvt_pk_bf16_f32 v13, v33, 0
    v_lshlrev_b32 v34, 16, v13
    v_sub_f32 v34, v33, v34
    v_cvt_pk_bf16_f32 v12, v33, v34
    v_mov_b32 v14, 0
    v_mov_b32 v15, 0
    v_mov_b32 v244, v37
    v_mov_b32 v250, v39
    v_mfma_f32_32x32x16_bf16 v[64:79], v[8:11], v[40:43], v[64:79]
    v_rsq_f32 v241, v244
    s_nop 0
    v_mul_f32 v240, s74, v241
    v_mfma_f32_32x32x16_bf16 v[80:95], v[12:15], v[40:43], v[80:95]
    v_mul_f32 v242, v241, v241
    v_mul_f32 v242, v242, v241
    v_mul_f32 v242, s75, v242
    v_mfma_f32_32x32x16_bf16 v[96:111], v[8:11], v[44:47], v[96:111]
    v_rsq_f32 v247, v250
    s_nop 0
    v_mul_f32 v246, s74, v247
    v_mfma_f32_32x32x16_bf16 v[112:127], v[12:15], v[44:47], v[112:127]
    v_mul_f32 v248, v247, v247
    v_mul_f32 v248, v248, v247
    v_mul_f32 v248, s75, v248
    s_setprio 0
    s_nop 3
    v_mul_f32 v32, v64, v64
    v_mul_f32 v33, v65, v65
    v_mul_f32 v34, v66, v66
    v_mul_f32 v35, v67, v67
    v_mul_f32 v36, v68, v68
    v_mul_f32 v37, v69, v69
    v_mul_f32 v38, v70, v70
    v_mul_f32 v39, v71, v71
    v_fma_f32 v32, v32, v242, v240
    v_fma_f32 v33, v33, v242, v240
    v_fma_f32 v34, v34, v242, v240
    v_fma_f32 v35, v35, v242, v240
    v_fma_f32 v36, v36, v242, v240
    v_fma_f32 v37, v37, v242, v240
    v_fma_f32 v38, v38, v242, v240
    v_fma_f32 v39, v39, v242, v240
    v_mul_f32 v32, v32, v64
    v_mul_f32 v33, v33, v65
    v_mul_f32 v34, v34, v66
    v_mul_f32 v35, v35, v67
    v_mul_f32 v36, v36, v68
    v_mul_f32 v37, v37, v69
    v_mul_f32 v38, v38, v70
    v_mul_f32 v39, v39, v71
    v_exp_f32 v32, v32
    v_mul_f32 v80, v64, v80
    v_exp_f32 v33, v33
    v_mul_f32 v81, v65, v81
    v_exp_f32 v34, v34
    v_mul_f32 v82, v66, v82
    v_exp_f32 v35, v35
    v_mul_f32 v83, v67, v83
    v_exp_f32 v36, v36
    v_mul_f32 v84, v68, v84
    v_exp_f32 v37, v37
    v_mul_f32 v85, v69, v85
    v_exp_f32 v38, v38
    v_mul_f32 v86, v70, v86
    v_exp_f32 v39, v39
    v_mul_f32 v87, v71, v87
    v_fma_f32 v32, v32, v244, v244
    v_fma_f32 v33, v33, v244, v244
    v_fma_f32 v34, v34, v244, v244
    v_fma_f32 v35, v35, v244, v244
    v_fma_f32 v36, v36, v244, v244
    v_fma_f32 v37, v37, v244, v244
    v_fma_f32 v38, v38, v244, v244
    v_fma_f32 v39, v39, v244, v244
    v_rcp_f32 v32, v32
    v_rcp_f32 v33, v33
    v_rcp_f32 v34, v34
    v_rcp_f32 v35, v35
    v_rcp_f32 v36, v36
    v_rcp_f32 v37, v37
    v_rcp_f32 v38, v38
    v_rcp_f32 v39, v39
    v_mul_f32 v80, v80, v32
    v_mul_f32 v81, v81, v33
    v_mul_f32 v82, v82, v34
    v_mul_f32 v83, v83, v35
    v_mul_f32 v84, v84, v36
    v_mul_f32 v85, v85, v37
    v_mul_f32 v86, v86, v38
    v_mul_f32 v87, v87, v39
    v_cvt_pk_bf16_f32 v48, v80, v81
    v_cvt_pk_bf16_f32 v49, v82, v83
    v_cvt_pk_bf16_f32 v50, v84, v85
    v_cvt_pk_bf16_f32 v51, v86, v87
    buffer_store_dwordx4 v[48:51], v2, s[52:55], s79 offen offset:0 sc1
    s_waitcnt vmcnt(1)
    v_mov_b32 v28, 151552
    v_mov_b32 v29, 1
    s_mov_b64 exec, 1
    ds_add_u32 v28, v29
    s_mov_b64 exec, -1
    v_add_u32 v10, s70, v2
    v_mul_f32 v40, v72, v72
    v_mul_f32 v41, v73, v73
    v_mul_f32 v42, v74, v74
    v_mul_f32 v43, v75, v75
    v_mul_f32 v44, v76, v76
    v_mul_f32 v45, v77, v77
    v_mul_f32 v46, v78, v78
    v_mul_f32 v47, v79, v79
    v_fma_f32 v40, v40, v242, v240
    v_fma_f32 v41, v41, v242, v240
    v_fma_f32 v42, v42, v242, v240
    v_fma_f32 v43, v43, v242, v240
    v_fma_f32 v44, v44, v242, v240
    v_fma_f32 v45, v45, v242, v240
    v_fma_f32 v46, v46, v242, v240
    v_fma_f32 v47, v47, v242, v240
    v_mul_f32 v40, v40, v72
    v_mul_f32 v41, v41, v73
    v_mul_f32 v42, v42, v74
    v_mul_f32 v43, v43, v75
    v_mul_f32 v44, v44, v76
    v_mul_f32 v45, v45, v77
    v_mul_f32 v46, v46, v78
    v_mul_f32 v47, v47, v79
    v_exp_f32 v40, v40
    v_mul_f32 v88, v72, v88
    v_exp_f32 v41, v41
    v_mul_f32 v89, v73, v89
    v_exp_f32 v42, v42
    v_mul_f32 v90, v74, v90
    v_exp_f32 v43, v43
    v_mul_f32 v91, v75, v91
    v_exp_f32 v44, v44
    v_mul_f32 v92, v76, v92
    v_exp_f32 v45, v45
    v_mul_f32 v93, v77, v93
    v_exp_f32 v46, v46
    v_mul_f32 v94, v78, v94
    v_exp_f32 v47, v47
    v_mul_f32 v95, v79, v95
    v_fma_f32 v40, v40, v244, v244
    v_fma_f32 v41, v41, v244, v244
    v_fma_f32 v42, v42, v244, v244
    v_fma_f32 v43, v43, v244, v244
    v_fma_f32 v44, v44, v244, v244
    v_fma_f32 v45, v45, v244, v244
    v_fma_f32 v46, v46, v244, v244
    v_fma_f32 v47, v47, v244, v244
    v_rcp_f32 v40, v40
    v_rcp_f32 v41, v41
    v_rcp_f32 v42, v42
    v_rcp_f32 v43, v43
    v_rcp_f32 v44, v44
    v_rcp_f32 v45, v45
    v_rcp_f32 v46, v46
    v_rcp_f32 v47, v47
    v_mul_f32 v88, v88, v40
    v_mul_f32 v89, v89, v41
    v_mul_f32 v90, v90, v42
    v_mul_f32 v91, v91, v43
    v_mul_f32 v92, v92, v44
    v_mul_f32 v93, v93, v45
    v_mul_f32 v94, v94, v46
    v_mul_f32 v95, v95, v47
    v_cvt_pk_bf16_f32 v52, v88, v89
    v_cvt_pk_bf16_f32 v53, v90, v91
    v_cvt_pk_bf16_f32 v54, v92, v93
    v_cvt_pk_bf16_f32 v55, v94, v95
    buffer_store_dwordx4 v[52:55], v2, s[52:55], s79 offen offset:1024 sc1
    buffer_load_dwordx2 v[16:17], v18, s[52:55], s12 offen sc1
    v_mul_f32 v32, v96, v96
    v_mul_f32 v33, v97, v97
    v_mul_f32 v34, v98, v98
    v_mul_f32 v35, v99, v99
    v_mul_f32 v36, v100, v100
    v_mul_f32 v37, v101, v101
    v_mul_f32 v38, v102, v102
    v_mul_f32 v39, v103, v103
    v_fma_f32 v32, v32, v248, v246
    v_fma_f32 v33, v33, v248, v246
    v_fma_f32 v34, v34, v248, v246
    v_fma_f32 v35, v35, v248, v246
    v_fma_f32 v36, v36, v248, v246
    v_fma_f32 v37, v37, v248, v246
    v_fma_f32 v38, v38, v248, v246
    v_fma_f32 v39, v39, v248, v246
    v_mul_f32 v32, v32, v96
    v_mul_f32 v33, v33, v97
    v_mul_f32 v34, v34, v98
    v_mul_f32 v35, v35, v99
    v_mul_f32 v36, v36, v100
    v_mul_f32 v37, v37, v101
    v_mul_f32 v38, v38, v102
    v_mul_f32 v39, v39, v103
    v_exp_f32 v32, v32
    v_mul_f32 v112, v96, v112
    v_exp_f32 v33, v33
    v_mul_f32 v113, v97, v113
    v_exp_f32 v34, v34
    v_mul_f32 v114, v98, v114
    v_exp_f32 v35, v35
    v_mul_f32 v115, v99, v115
    v_exp_f32 v36, v36
    v_mul_f32 v116, v100, v116
    v_exp_f32 v37, v37
    v_mul_f32 v117, v101, v117
    v_exp_f32 v38, v38
    v_mul_f32 v118, v102, v118
    v_exp_f32 v39, v39
    v_mul_f32 v119, v103, v119
    v_fma_f32 v32, v32, v250, v250
    v_fma_f32 v33, v33, v250, v250
    v_fma_f32 v34, v34, v250, v250
    v_fma_f32 v35, v35, v250, v250
    v_fma_f32 v36, v36, v250, v250
    v_fma_f32 v37, v37, v250, v250
    v_fma_f32 v38, v38, v250, v250
    v_fma_f32 v39, v39, v250, v250
    v_rcp_f32 v32, v32
    v_rcp_f32 v33, v33
    v_rcp_f32 v34, v34
    v_rcp_f32 v35, v35
    v_rcp_f32 v36, v36
    v_rcp_f32 v37, v37
    v_rcp_f32 v38, v38
    v_rcp_f32 v39, v39
    v_mul_f32 v112, v112, v32
    v_mul_f32 v113, v113, v33
    v_mul_f32 v114, v114, v34
    v_mul_f32 v115, v115, v35
    v_mul_f32 v116, v116, v36
    v_mul_f32 v117, v117, v37
    v_mul_f32 v118, v118, v38
    v_mul_f32 v119, v119, v39
    v_cvt_pk_bf16_f32 v56, v112, v113
    v_cvt_pk_bf16_f32 v57, v114, v115
    v_cvt_pk_bf16_f32 v58, v116, v117
    v_cvt_pk_bf16_f32 v59, v118, v119
    buffer_store_dwordx4 v[56:59], v2, s[52:55], s80 offen offset:0 sc1
    v_mul_f32 v40, v104, v104
    v_mul_f32 v41, v105, v105
    v_mul_f32 v42, v106, v106
    v_mul_f32 v43, v107, v107
    v_mul_f32 v44, v108, v108
    v_mul_f32 v45, v109, v109
    v_mul_f32 v46, v110, v110
    v_mul_f32 v47, v111, v111
    v_fma_f32 v40, v40, v248, v246
    v_fma_f32 v41, v41, v248, v246
    v_fma_f32 v42, v42, v248, v246
    v_fma_f32 v43, v43, v248, v246
    v_fma_f32 v44, v44, v248, v246
    v_fma_f32 v45, v45, v248, v246
    v_fma_f32 v46, v46, v248, v246
    v_fma_f32 v47, v47, v248, v246
    v_mul_f32 v40, v40, v104
    v_mul_f32 v41, v41, v105
    v_mul_f32 v42, v42, v106
    v_mul_f32 v43, v43, v107
    v_mul_f32 v44, v44, v108
    v_mul_f32 v45, v45, v109
    v_mul_f32 v46, v46, v110
    v_mul_f32 v47, v47, v111
    v_exp_f32 v40, v40
    v_mul_f32 v120, v104, v120
    v_exp_f32 v41, v41
    v_mul_f32 v121, v105, v121
    v_exp_f32 v42, v42
    v_mul_f32 v122, v106, v122
    v_exp_f32 v43, v43
    v_mul_f32 v123, v107, v123
    v_exp_f32 v44, v44
    v_mul_f32 v124, v108, v124
    v_exp_f32 v45, v45
    v_mul_f32 v125, v109, v125
    v_exp_f32 v46, v46
    v_mul_f32 v126, v110, v126
    v_exp_f32 v47, v47
    v_mul_f32 v127, v111, v127
    v_fma_f32 v40, v40, v250, v250
    v_fma_f32 v41, v41, v250, v250
    v_fma_f32 v42, v42, v250, v250
    v_fma_f32 v43, v43, v250, v250
    v_fma_f32 v44, v44, v250, v250
    v_fma_f32 v45, v45, v250, v250
    v_fma_f32 v46, v46, v250, v250
    v_fma_f32 v47, v47, v250, v250
    v_rcp_f32 v40, v40
    v_rcp_f32 v41, v41
    v_rcp_f32 v42, v42
    v_rcp_f32 v43, v43
    v_rcp_f32 v44, v44
    v_rcp_f32 v45, v45
    v_rcp_f32 v46, v46
    v_rcp_f32 v47, v47
    v_mul_f32 v120, v120, v40
    v_mul_f32 v121, v121, v41
    v_mul_f32 v122, v122, v42
    v_mul_f32 v123, v123, v43
    v_mul_f32 v124, v124, v44
    v_mul_f32 v125, v125, v45
    v_mul_f32 v126, v126, v46
    v_mul_f32 v127, v127, v47
    v_cvt_pk_bf16_f32 v60, v120, v121
    v_cvt_pk_bf16_f32 v61, v122, v123
    v_cvt_pk_bf16_f32 v62, v124, v125
    v_cvt_pk_bf16_f32 v63, v126, v127
    buffer_store_dwordx4 v[60:63], v2, s[52:55], s80 offen offset:1024 sc1
    s_waitcnt vmcnt(2)
    s_mov_b32 s71, 0
kAw_chk:
    v_cmp_ne_u64 vcc, s[18:19], v[16:17]
    s_cbranch_vccz kAw_ok
    buffer_load_dwordx2 v[16:17], v18, s[52:55], s12 offen sc1
    s_add_u32 s71, s71, 1
    s_cmp_gt_u32 s71, 262144
    s_waitcnt vmcnt(0)
    s_cbranch_scc0 kAw_chk
kAw_ok:
    s_setprio 2
    s_lshl_b32 s72, s83, 12
    s_add_u32 s72, s72, s82
    buffer_load_dwordx4 v[128:131], v5, s[52:55], s72 offen offset:0 sc1
    buffer_load_dwordx4 v[132:135], v6, s[52:55], s72 offen offset:0 sc1
    buffer_load_dwordx4 v[136:139], v5, s[52:55], s72 offen offset:2048 sc1
    buffer_load_dwordx4 v[140:143], v6, s[52:55], s72 offen offset:2048 sc1
    s_add_u32 s83, s83, 1
    s_cmp_eq_u32 s83, 7
    s_cselect_b32 s83, 0, s83
    s_lshl_b32 s72, s83, 12
    s_add_u32 s72, s72, s82
    buffer_load_dwordx4 v[144:147], v5, s[52:55], s72 offen offset:0 sc1
    buffer_load_dwordx4 v[148:151], v6, s[52:55], s72 offen offset:0 sc1
    buffer_load_dwordx4 v[152:155], v5, s[52:55], s72 offen offset:2048 sc1
    buffer_load_dwordx4 v[156:159], v6, s[52:55], s72 offen offset:2048 sc1
    s_add_u32 s83, s83, 1
    s_cmp_eq_u32 s83, 7
    s_cselect_b32 s83, 0, s83
    s_waitcnt vmcnt(8)
    s_lshl_b32 s71, s61, 4
    s_add_u32 s71, s71, s62
    s_lshl_b32 s71, s71, 3
    s_add_u32 s71, s71, s60
    s_lshl_b32 s71, s71, 7
    s_add_u32 s71, s71, 9437184
    v_lshlrev_b32 v28, 3, v1
    s_mov_b64 exec, 0xffff
    buffer_store_dwordx2 v[30:31], v28, s[52:55], s71 offen sc0 sc1
    s_mov_b64 exec, -1
    s_lshl_b32 s72, s83, 12
    s_add_u32 s72, s72, s82
    buffer_load_dwordx4 v[160:163], v5, s[52:55], s72 offen offset:0 sc1
    buffer_load_dwordx4 v[164:167], v6, s[52:55], s72 offen offset:0 sc1
    buffer_load_dwordx4 v[168:171], v5, s[52:55], s72 offen offset:2048 sc1
    buffer_load_dwordx4 v[172:175], v6, s[52:55], s72 offen offset:2048 sc1
    s_add_u32 s83, s83, 1
    s_cmp_eq_u32 s83, 7
    s_cselect_b32 s83, 0, s83
    s_lshl_b32 s72, s83, 12
    s_add_u32 s72, s72, s82
    buffer_load_dwordx4 v[176:179], v5, s[52:55], s72 offen offset:0 sc1
    buffer_load_dwordx4 v[180:183], v6, s[52:55], s72 offen offset:0 sc1
    buffer_load_dwordx4 v[184:187], v5, s[52:55], s72 offen offset:2048 sc1
    buffer_load_dwordx4 v[188:191], v6, s[52:55], s72 offen offset:2048 sc1
    s_add_u32 s83, s83, 1
    s_cmp_eq_u32 s83, 7
    s_cselect_b32 s83, 0, s83
    ds_write_b128 v10, v[208:211] offset:0
    ds_write_b128 v10, v[212:215] offset:1024
    ds_write_b128 v10, v[216:219] offset:2048
    ds_write_b128 v10, v[220:223] offset:3072
    ds_write_b128 v10, v[224:227] offset:49152
    ds_write_b128 v10, v[228:231] offset:50176
    ds_write_b128 v10, v[232:235] offset:51200
    ds_write_b128 v10, v[236:239] offset:52224
    s_lshl_b32 s72, s83, 12
    s_add_u32 s72, s72, s82
    buffer_load_dwordx4 v[192:195], v5, s[52:55], s72 offen offset:0 sc1
    buffer_load_dwordx4 v[196:199], v6, s[52:55], s72 offen offset:0 sc1
    buffer_load_dwordx4 v[200:203], v5, s[52:55], s72 offen offset:2048 sc1
    buffer_load_dwordx4 v[204:207], v6, s[52:55], s72 offen offset:2048 sc1
    s_add_u32 s83, s83, 1
    s_cmp_eq_u32 s83, 7
    s_cselect_b32 s83, 0, s83
    s_waitcnt lgkmcnt(0)
    s_lshl_b32 s72, s83, 12
    s_add_u32 s72, s72, s82
    buffer_load_dwordx4 v[208:211], v5, s[52:55], s72 offen offset:0 sc1
    buffer_load_dwordx4 v[212:215], v6, s[52:55], s72 offen offset:0 sc1
    buffer_load_dwordx4 v[216:219], v5, s[52:55], s72 offen offset:2048 sc1
    buffer_load_dwordx4 v[220:223], v6, s[52:55], s72 offen offset:2048 sc1
    s_add_u32 s83, s83, 1
    s_cmp_eq_u32 s83, 7
    s_cselect_b32 s83, 0, s83
    s_lshl_b32 s72, s83, 12
    s_add_u32 s72, s72, s82
    buffer_load_dwordx4 v[224:227], v5, s[52:55], s72 offen offset:0 sc1
    buffer_load_dwordx4 v[228:231], v6, s[52:55], s72 offen offset:0 sc1
    buffer_load_dwordx4 v[232:235], v5, s[52:55], s72 offen offset:2048 sc1
    buffer_load_dwordx4 v[236:239], v6, s[52:55], s72 offen offset:2048 sc1
    s_add_u32 s83, s83, 1
    s_cmp_eq_u32 s83, 7
    s_cselect_b32 s83, 0, s83
    s_lshr_b32 s71, s63, 1
    s_lshl_b32 s71, s71, 5
    s_add_u32 s71, s71, s65
    s_xor_b32 s73, s71, 32
    s_mul_i32 s79, s71, 57344
    s_mul_i32 s80, s73, 57344
    s_mul_i32 s71, s63, 14336
    s_add_u32 s71, s71, 0
    s_add_u32 s79, s79, s71
    s_add_u32 s80, s80, s71
    s_mul_i32 s71, s63, 7
    v_and_b32 v8, 7, v1
    v_min_u32 v8, 6, v8
    v_add_u32 v8, s71, v8
    v_lshrrev_b32 v10, 1, v8
    v_bfe_u32 v9, v1, 3, 1
    v_lshl_add_u32 v10, v9, 7, v10
    s_lshr_b32 s73, s65, 2
    s_lshl_b32 s73, s73, 4
    v_add_lshl_u32 v10, v10, s73, 3
    v_and_b32 v8, 1, v8
    s_and_b32 s71, s65, 2
    v_add3_u32 v8, v8, v10, s71
    v_lshlrev_b32 v8, 7, v8
    s_mov_b32 s12, 9437184
    buffer_load_dwordx2 v[16:17], v8, s[52:55], s12 offen sc1
    v_bfe_u32 v9, v1, 1, 4
    v_lshlrev_b32 v9, 4, v9
    v_and_b32 v11, 1, v1
    v_add3_u32 v9, v9, v11, 14
    v_lshlrev_b32 v9, 10, v9
    v_add_u32 v10, s70, v2
    s_waitcnt vmcnt(0)
    s_mov_b32 s71, 0
kAh_chk:
    v_cmp_ne_u64 vcc, s[18:19], v[16:17]
    s_cbranch_vccz kAh_ok
    buffer_load_dwordx2 v[16:17], v8, s[52:55], s12 offen sc1
    s_add_u32 s71, s71, 1
    s_cmp_gt_u32 s71, 262144
    s_waitcnt vmcnt(0)
    s_cbranch_scc0 kAh_chk
kAh_ok:
    s_lshl_b32 s71, s81, 11
    s_add_u32 s72, s71, s79
    s_add_u32 s73, s71, s80
    s_add_u32 s81, s81, 1
    s_cmp_eq_u32 s81, 7
    s_cselect_b32 s81, 0, s81
    buffer_load_dwordx4 v[32:35], v2, s[52:55], s72 offen offset:0 sc1
    buffer_load_dwordx4 v[36:39], v2, s[52:55], s73 offen offset:0 sc1
    buffer_load_dwordx4 v[40:43], v2, s[52:55], s72 offen offset:1024 sc1
    buffer_load_dwordx4 v[44:47], v2, s[52:55], s73 offen offset:1024 sc1
    s_lshl_b32 s71, s81, 11
    s_add_u32 s72, s71, s79
    s_add_u32 s73, s71, s80
    s_add_u32 s81, s81, 1
    s_cmp_eq_u32 s81, 7
    s_cselect_b32 s81, 0, s81
    buffer_load_dwordx4 v[48:51], v2, s[52:55], s72 offen offset:0 sc1
    buffer_load_dwordx4 v[52:55], v2, s[52:55], s73 offen offset:0 sc1
    buffer_load_dwordx4 v[56:59], v2, s[52:55], s72 offen offset:1024 sc1
    buffer_load_dwordx4 v[60:63], v2, s[52:55], s73 offen offset:1024 sc1
    s_lshl_b32 s71, s81, 11
    s_add_u32 s72, s71, s79
    s_add_u32 s73, s71, s80
    s_add_u32 s81, s81, 1
    s_cmp_eq_u32 s81, 7
    s_cselect_b32 s81, 0, s81
    buffer_load_dwordx4 v[240:243], v2, s[52:55], s72 offen offset:0 sc1
    buffer_load_dwordx4 v[244:247], v2, s[52:55], s73 offen offset:0 sc1
    buffer_load_dwordx4 v[248:251], v2, s[52:55], s72 offen offset:1024 sc1
    buffer_load_dwordx4 v[252:255], v2, s[52:55], s73 offen offset:1024 sc1
    s_waitcnt vmcnt(11)
    v_mfma_f32_32x32x16_bf16 v[64:79], v[128:131], v[32:35], 0
    v_mfma_f32_32x32x16_bf16 v[80:95], v[132:135], v[32:35], 0
    s_lshl_b32 s71, s81, 11
    s_add_u32 s72, s71, s79
    s_add_u32 s73, s71, s80
    s_add_u32 s81, s81, 1
    s_cmp_eq_u32 s81, 7
    s_cselect_b32 s81, 0, s81
    buffer_load_dwordx4 v[32:35], v2, s[52:55], s72 offen offset:0 sc1
    s_waitcnt vmcnt(11)
    v_mfma_f32_32x32x16_bf16 v[96:111], v[128:131], v[36:39], 0
    v_mfma_f32_32x32x16_bf16 v[112:127], v[132:135], v[36:39], 0
    buffer_load_dwordx4 v[36:39], v2, s[52:55], s73 offen offset:0 sc1
    buffer_load_dwordx4 v[128:131], v2, s[52:55], s72 offen offset:1024 sc1
    buffer_load_dwordx4 v[132:135], v2, s[52:55], s73 offen offset:1024 sc1
    s_waitcnt vmcnt(13)
    v_mfma_f32_32x32x16_bf16 v[64:79], v[136:139], v[40:43], v[64:79]
    v_mfma_f32_32x32x16_bf16 v[80:95], v[140:143], v[40:43], v[80:95]
    s_lshl_b32 s71, s81, 11
    s_add_u32 s72, s71, s79
    s_add_u32 s73, s71, s80
    s_add_u32 s81, s81, 1
    s_cmp_eq_u32 s81, 7
    s_cselect_b32 s81, 0, s81
    buffer_load_dwordx4 v[40:43], v2, s[52:55], s72 offen offset:0 sc1
    s_waitcnt vmcnt(13)
    v_mfma_f32_32x32x16_bf16 v[96:111], v[136:139], v[44:47], v[96:111]
    v_mfma_f32_32x32x16_bf16 v[112:127], v[140:143], v[44:47], v[112:127]
    buffer_load_dwordx4 v[44:47], v2, s[52:55], s73 offen offset:0 sc1
    buffer_load_dwordx4 v[136:139], v2, s[52:55], s72 offen offset:1024 sc1
    buffer_load_dwordx4 v[140:143], v2, s[52:55], s73 offen offset:1024 sc1
    s_waitcnt vmcnt(15)
    v_mfma_f32_32x32x16_bf16 v[64:79], v[144:147], v[48:51], v[64:79]
    v_mfma_f32_32x32x16_bf16 v[80:95], v[148:151], v[48:51], v[80:95]
    s_lshl_b32 s71, s81, 11
    s_add_u32 s72, s71, s79
    s_add_u32 s73, s71, s80
    s_add_u32 s81, s81, 1
    s_cmp_eq_u32 s81, 7
    s_cselect_b32 s81, 0, s81
    buffer_load_dwordx4 v[48:51], v2, s[52:55], s72 offen offset:0 sc1
    s_waitcnt vmcnt(15)
    v_mfma_f32_32x32x16_bf16 v[96:111], v[144:147], v[52:55], v[96:111]
    v_mfma_f32_32x32x16_bf16 v[112:127], v[148:151], v[52:55], v[112:127]
    buffer_load_dwordx4 v[52:55], v2, s[52:55], s73 offen offset:0 sc1
    buffer_load_dwordx4 v[144:147], v2, s[52:55], s72 offen offset:1024 sc1
    buffer_load_dwordx4 v[148:151], v2, s[52:55], s73 offen offset:1024 sc1
    s_waitcnt vmcnt(17)
    v_mfma_f32_32x32x16_bf16 v[64:79], v[152:155], v[56:59], v[64:79]
    v_mfma_f32_32x32x16_bf16 v[80:95], v[156:159], v[56:59], v[80:95]
    s_lshl_b32 s71, s81, 11
    s_add_u32 s72, s71, s79
    s_add_u32 s73, s71, s80
    s_add_u32 s81, s81, 1
    s_cmp_eq_u32 s81, 7
    s_cselect_b32 s81, 0, s81
    buffer_load_dwordx4 v[56:59], v2, s[52:55], s72 offen offset:0 sc1
    s_waitcnt vmcnt(17)
    v_mfma_f32_32x32x16_bf16 v[96:111], v[152:155], v[60:63], v[96:111]
    v_mfma_f32_32x32x16_bf16 v[112:127], v[156:159], v[60:63], v[112:127]
    buffer_load_dwordx4 v[60:63], v2, s[52:55], s73 offen offset:0 sc1
    buffer_load_dwordx4 v[152:155], v2, s[52:55], s72 offen offset:1024 sc1
    buffer_load_dwordx4 v[156:159], v2, s[52:55], s73 offen offset:1024 sc1
    s_waitcnt vmcnt(19)
    v_mfma_f32_32x32x16_bf16 v[64:79], v[160:163], v[240:243], v[64:79]
    v_mfma_f32_32x32x16_bf16 v[80:95], v[164:167], v[240:243], v[80:95]
    s_waitcnt vmcnt(18)
    v_mfma_f32_32x32x16_bf16 v[96:111], v[160:163], v[244:247], v[96:111]
    v_mfma_f32_32x32x16_bf16 v[112:127], v[164:167], v[244:247], v[112:127]
    s_waitcnt vmcnt(17)
    v_mfma_f32_32x32x16_bf16 v[64:79], v[168:171], v[248:251], v[64:79]
    v_mfma_f32_32x32x16_bf16 v[80:95], v[172:175], v[248:251], v[80:95]
    s_waitcnt vmcnt(16)
    v_mfma_f32_32x32x16_bf16 v[96:111], v[168:171], v[252:255], v[96:111]
    v_mfma_f32_32x32x16_bf16 v[112:127], v[172:175], v[252:255], v[112:127]
    s_waitcnt vmcnt(15)
    v_mfma_f32_32x32x16_bf16 v[64:79], v[176:179], v[32:35], v[64:79]
    v_mfma_f32_32x32x16_bf16 v[80:95], v[180:183], v[32:35], v[80:95]
    s_waitcnt vmcnt(14)
    v_mfma_f32_32x32x16_bf16 v[96:111], v[176:179], v[36:39], v[96:111]
    v_mfma_f32_32x32x16_bf16 v[112:127], v[180:183], v[36:39], v[112:127]
    s_waitcnt vmcnt(13)
    v_mfma_f32_32x32x16_bf16 v[64:79], v[184:187], v[128:131], v[64:79]
    v_mfma_f32_32x32x16_bf16 v[80:95], v[188:191], v[128:131], v[80:95]
    s_waitcnt vmcnt(12)
    v_mfma_f32_32x32x16_bf16 v[96:111], v[184:187], v[132:135], v[96:111]
    v_mfma_f32_32x32x16_bf16 v[112:127], v[188:191], v[132:135], v[112:127]
    s_waitcnt vmcnt(11)
    v_mfma_f32_32x32x16_bf16 v[64:79], v[192:195], v[40:43], v[64:79]
    v_mfma_f32_32x32x16_bf16 v[80:95], v[196:199], v[40:43], v[80:95]
    buffer_load_dwordx2 v[16:17], v9, s[52:55], s12 offen sc1
    s_waitcnt vmcnt(11)
    v_mfma_f32_32x32x16_bf16 v[96:111], v[192:195], v[44:47], v[96:111]
    v_mfma_f32_32x32x16_bf16 v[112:127], v[196:199], v[44:47], v[112:127]
    s_waitcnt vmcnt(10)
    v_mfma_f32_32x32x16_bf16 v[64:79], v[200:203], v[136:139], v[64:79]
    v_mfma_f32_32x32x16_bf16 v[80:95], v[204:207], v[136:139], v[80:95]
    buffer_load_dwordx2 v[192:193], v3, s[40:43], s8 offen offset:0
    buffer_load_dwordx2 v[194:195], v3, s[40:43], s8 offen offset:16
    s_waitcnt vmcnt(11)
    v_mfma_f32_32x32x16_bf16 v[96:111], v[200:203], v[140:143], v[96:111]
    v_mfma_f32_32x32x16_bf16 v[112:127], v[204:207], v[140:143], v[112:127]
    buffer_load_dwordx2 v[196:197], v3, s[40:43], s8 offen offset:32
    buffer_load_dwordx2 v[198:199], v3, s[40:43], s8 offen offset:48
    s_waitcnt vmcnt(12)
    v_mfma_f32_32x32x16_bf16 v[64:79], v[208:211], v[48:51], v[64:79]
    v_mfma_f32_32x32x16_bf16 v[80:95], v[212:215], v[48:51], v[80:95]
    s_waitcnt vmcnt(11)
    v_mfma_f32_32x32x16_bf16 v[96:111], v[208:211], v[52:55], v[96:111]
    v_mfma_f32_32x32x16_bf16 v[112:127], v[212:215], v[52:55], v[112:127]
    s_waitcnt vmcnt(10)
    v_mfma_f32_32x32x16_bf16 v[64:79], v[216:219], v[144:147], v[64:79]
    v_mfma_f32_32x32x16_bf16 v[80:95], v[220:223], v[144:147], v[80:95]
    s_waitcnt vmcnt(4)
    s_mov_b32 s74, 0
kAz_chk:
    v_cmp_ne_u64 vcc, s[18:19], v[16:17]
    s_cbranch_vccz kAz_ok
    buffer_load_dwordx2 v[16:17], v9, s[52:55], s12 offen sc1
    s_add_u32 s74, s74, 1
    s_cmp_gt_u32 s74, 262144
    s_waitcnt vmcnt(0)
    s_cbranch_scc0 kAz_chk
kAz_ok:
    buffer_load_dwordx4 v[160:163], v7, s[20:23], s14 offen sc1
    s_add_u32 s14, s14, 229376
    buffer_load_dwordx4 v[164:167], v7, s[20:23], s14 offen sc1
    s_add_u32 s14, s14, 229376
    buffer_load_dwordx4 v[168:171], v7, s[20:23], s14 offen sc1
    s_add_u32 s14, s14, 229376
    buffer_load_dwordx4 v[172:175], v7, s[20:23], s14 offen sc1
    s_add_u32 s14, s14, 229376
    v_mfma_f32_32x32x16_bf16 v[96:111], v[216:219], v[148:151], v[96:111]
    v_mfma_f32_32x32x16_bf16 v[112:127], v[220:223], v[148:151], v[112:127]
    buffer_load_dwordx4 v[176:179], v7, s[20:23], s14 offen sc1
    s_add_u32 s14, s14, 229376
    buffer_load_dwordx4 v[180:183], v7, s[20:23], s14 offen sc1
    s_add_u32 s14, s14, 229376
    buffer_load_dwordx4 v[184:187], v7, s[20:23], s14 offen sc1
    s_add_u32 s14, s14, 229376
    buffer_load_dwordx4 v[188:191], v7, s[20:23], s14 offen sc1
    v_mfma_f32_32x32x16_bf16 v[64:79], v[224:227], v[56:59], v[64:79]
    v_mfma_f32_32x32x16_bf16 v[80:95], v[228:231], v[56:59], v[80:95]
    v_mfma_f32_32x32x16_bf16 v[96:111], v[224:227], v[60:63], v[96:111]
    v_mfma_f32_32x32x16_bf16 v[112:127], v[228:231], v[60:63], v[112:127]
    v_mfma_f32_32x32x16_bf16 v[64:79], v[232:235], v[152:155], v[64:79]
    v_mfma_f32_32x32x16_bf16 v[80:95], v[236:239], v[152:155], v[80:95]
    v_mfma_f32_32x32x16_bf16 v[96:111], v[232:235], v[156:159], v[96:111]
    v_mfma_f32_32x32x16_bf16 v[112:127], v[236:239], v[156:159], v[112:127]
    ds_read_b128 v[208:211], v10 offset:0
    ds_read_b128 v[212:215], v10 offset:1024
    ds_read_b128 v[216:219], v10 offset:2048
    ds_read_b128 v[220:223], v10 offset:3072
    ds_read_b128 v[224:227], v10 offset:49152
    ds_read_b128 v[228:231], v10 offset:50176
    ds_read_b128 v[232:235], v10 offset:51200
    ds_read_b128 v[236:239], v10 offset:52224
    s_nop 9
    ds_write_b128 v10, v[80:83] offset:0
    ds_write_b128 v10, v[84:87] offset:1024
    ds_write_b128 v10, v[88:91] offset:2048
    ds_write_b128 v10, v[92:95] offset:3072
    ds_write_b128 v10, v[112:115] offset:49152
    ds_write_b128 v10, v[116:119] offset:50176
    ds_write_b128 v10, v[120:123] offset:51200
    ds_write_b128 v10, v[124:127] offset:52224
    v_mov_b32 v28, 151560
    v_mov_b32 v29, 1
    s_mov_b64 exec, 1
    ds_add_u32 v28, v29
    s_mov_b64 exec, -1
    s_waitcnt lgkmcnt(9)
    s_waitcnt vmcnt(7)
    v_mfma_f32_32x32x16_bf16 v[128:143], v[160:163], v[208:211], 0
    s_waitcnt vmcnt(6)
    v_mfma_f32_32x32x16_bf16 v[128:143], v[164:167], v[212:215], v[128:143]
    s_waitcnt vmcnt(5)
    v_mfma_f32_32x32x16_bf16 v[128:143], v[168:171], v[216:219], v[128:143]
    s_waitcnt vmcnt(4)
    v_mfma_f32_32x32x16_bf16 v[128:143], v[172:175], v[220:223], v[128:143]
    s_waitcnt vmcnt(3)
    v_mfma_f32_32x32x16_bf16 v[128:143], v[176:179], v[224:227], v[128:143]
    s_waitcnt vmcnt(2)
    v_mfma_f32_32x32x16_bf16 v[128:143], v[180:183], v[228:231], v[128:143]
    s_waitcnt vmcnt(1)
    v_mfma_f32_32x32x16_bf16 v[128:143], v[184:187], v[232:235], v[128:143]
    s_waitcnt vmcnt(0)
    v_mfma_f32_32x32x16_bf16 v[128:143], v[188:191], v[236:239], v[128:143]
    v_mov_b32 v28, 151560
    s_mov_b32 s71, 0
kAr1_sp:
    ds_read_b32 v29, v28
    s_add_u32 s71, s71, 1
    s_cmp_gt_u32 s71, 4194304
    s_waitcnt lgkmcnt(0)
    s_cbranch_scc1 kAr1_sok
    v_cmp_ne_u32 vcc, 4, v29
    s_cbranch_vccnz kAr1_sp
kAr1_sok:
    v_xor_b32 v11, 0x1000, v10
    ds_read_b128 v[112:115], v11 offset:49152
    ds_read_b128 v[116:119], v11 offset:50176
    ds_read_b128 v[120:123], v11 offset:51200
    ds_read_b128 v[124:127], v11 offset:52224
    ds_read_b128 v[80:83], v11 offset:0
    ds_read_b128 v[84:87], v11 offset:1024
    ds_read_b128 v[88:91], v11 offset:2048
    ds_read_b128 v[92:95], v11 offset:3072
    s_waitcnt lgkmcnt(4)
    v_add_f32 v96, v96, v112
    v_add_f32 v97, v97, v113
    v_add_f32 v98, v98, v114
    v_add_f32 v99, v99, v115
    v_add_f32 v100, v100, v116
    v_add_f32 v101, v101, v117
    v_add_f32 v102, v102, v118
    v_add_f32 v103, v103, v119
    v_add_f32 v104, v104, v120
    v_add_f32 v105, v105, v121
    v_add_f32 v106, v106, v122
    v_add_f32 v107, v107, v123
    v_add_f32 v108, v108, v124
    v_add_f32 v109, v109, v125
    v_add_f32 v110, v110, v126
    v_add_f32 v111, v111, v127
    ds_write_b128 v11, v[96:99] offset:49152
    ds_write_b128 v11, v[100:103] offset:50176
    ds_write_b128 v11, v[104:107] offset:51200
    ds_write_b128 v11, v[108:111] offset:52224
    v_mov_b32 v28, 151564
    v_mov_b32 v29, 1
    s_mov_b64 exec, 1
    ds_add_u32 v28, v29
    s_mov_b64 exec, -1
    s_waitcnt lgkmcnt(5)
    v_add_f32 v64, v64, v80
    v_add_f32 v65, v65, v81
    v_add_f32 v66, v66, v82
    v_add_f32 v67, v67, v83
    v_add_f32 v68, v68, v84
    v_add_f32 v69, v69, v85
    v_add_f32 v70, v70, v86
    v_add_f32 v71, v71, v87
    v_add_f32 v72, v72, v88
    v_add_f32 v73, v73, v89
    v_add_f32 v74, v74, v90
    v_add_f32 v75, v75, v91
    v_add_f32 v76, v76, v92
    v_add_f32 v77, v77, v93
    v_add_f32 v78, v78, v94
    v_add_f32 v79, v79, v95
    v_lshlrev_b32 v32, 16, v192
    v_and_b32 v33, s76, v192
    v_lshlrev_b32 v34, 16, v193
    v_and_b32 v35, s76, v193
    v_lshlrev_b32 v36, 16, v194
    v_and_b32 v37, s76, v194
    v_lshlrev_b32 v38, 16, v195
    v_and_b32 v39, s76, v195
    v_lshlrev_b32 v40, 16, v196
    v_and_b32 v41, s76, v196
    v_lshlrev_b32 v42, 16, v197
    v_and_b32 v43, s76, v197
    v_lshlrev_b32 v44, 16, v198
    v_and_b32 v45, s76, v198
    v_lshlrev_b32 v46, 16, v199
    v_and_b32 v47, s76, v199
    v_mov_b32 v28, 151564
    s_mov_b32 s71, 0
kAr2_sp:
    ds_read_b32 v29, v28
    s_add_u32 s71, s71, 1
    s_cmp_gt_u32 s71, 4194304
    s_waitcnt lgkmcnt(0)
    s_cbranch_scc1 kAr2_sok
    v_cmp_ne_u32 vcc, 4, v29
    s_cbranch_vccnz kAr2_sp
kAr2_sok:
    v_xor_b32 v11, 0x3000, v10
    ds_read_b128 v[80:83], v11 offset:49152
    ds_read_b128 v[84:87], v11 offset:50176
    ds_read_b128 v[88:91], v11 offset:51200
    ds_read_b128 v[92:95], v11 offset:52224
    v_add_u32 v8, 0x14000, v10
    v_xor_b32 v13, 4096, v8
    v_xor_b32 v14, 8192, v8
    v_xor_b32 v15, 12288, v8
    s_mov_b32 s74, 0xbfb8aa3b
    s_mov_b32 s75, 0xbfb8aa3b
    s_waitcnt lgkmcnt(0)
    v_add_f32 v64, v64, v80
    v_add_f32 v65, v65, v81
    v_add_f32 v66, v66, v82
    v_add_f32 v67, v67, v83
    v_add_f32 v68, v68, v84
    v_add_f32 v69, v69, v85
    v_add_f32 v70, v70, v86
    v_add_f32 v71, v71, v87
    v_add_f32 v72, v72, v88
    v_add_f32 v73, v73, v89
    v_add_f32 v74, v74, v90
    v_add_f32 v75, v75, v91
    v_add_f32 v76, v76, v92
    v_add_f32 v77, v77, v93
    v_add_f32 v78, v78, v94
    v_add_f32 v79, v79, v95
    ds_write_b128 v10, v[72:75] offset:0
    ds_write_b128 v10, v[76:79] offset:1024
    ds_write_b128 v10, v[136:139] offset:2048
    ds_write_b128 v10, v[140:143] offset:3072
    ds_write_b128 v11, v[40:43] offset:49152
    ds_write_b128 v11, v[44:47] offset:50176
    s_waitcnt lgkmcnt(0)
    s_setprio 3
    s_barrier
    ds_read_b128 v[160:163], v8 offset:0
    ds_read_b128 v[164:167], v8 offset:1024
    ds_read_b128 v[80:83], v13 offset:16384
    ds_read_b128 v[84:87], v13 offset:17408
    ds_read_b128 v[96:99], v14 offset:32768
    ds_read_b128 v[100:103], v14 offset:33792
    ds_read_b128 v[112:115], v15 offset:49152
    ds_read_b128 v[116:119], v15 offset:50176
    s_waitcnt lgkmcnt(6)
    v_pk_add_f32 v[64:65], v[64:65], v[160:161]
    v_pk_add_f32 v[66:67], v[66:67], v[162:163]
    v_pk_add_f32 v[68:69], v[68:69], v[164:165]
    v_pk_add_f32 v[70:71], v[70:71], v[166:167]
    s_waitcnt lgkmcnt(4)
    v_pk_add_f32 v[64:65], v[64:65], v[80:81]
    v_pk_add_f32 v[66:67], v[66:67], v[82:83]
    v_pk_add_f32 v[68:69], v[68:69], v[84:85]
    v_pk_add_f32 v[70:71], v[70:71], v[86:87]
    s_waitcnt lgkmcnt(2)
    v_pk_add_f32 v[64:65], v[64:65], v[96:97]
    v_pk_add_f32 v[66:67], v[66:67], v[98:99]
    v_pk_add_f32 v[68:69], v[68:69], v[100:101]
    v_pk_add_f32 v[70:71], v[70:71], v[102:103]
    s_waitcnt lgkmcnt(0)
    v_pk_add_f32 v[64:65], v[64:65], v[112:113]
    v_pk_add_f32 v[66:67], v[66:67], v[114:115]
    v_pk_add_f32 v[68:69], v[68:69], v[116:117]
    v_pk_add_f32 v[70:71], v[70:71], v[118:119]
    v_pk_mul_f32 v[48:49], v[64:65], s[74:75]
    v_pk_mul_f32 v[50:51], v[66:67], s[74:75]
    v_pk_mul_f32 v[52:53], v[68:69], s[74:75]
    v_pk_mul_f32 v[54:55], v[70:71], s[74:75]
    v_exp_f32 v48, v48
    v_exp_f32 v49, v49
    v_exp_f32 v50, v50
    v_exp_f32 v51, v51
    v_exp_f32 v52, v52
    v_exp_f32 v53, v53
    v_exp_f32 v54, v54
    v_exp_f32 v55, v55
    v_pk_mul_f32 v[64:65], v[64:65], v[128:129]
    v_pk_mul_f32 v[66:67], v[66:67], v[130:131]
    v_pk_mul_f32 v[68:69], v[68:69], v[132:133]
    v_pk_mul_f32 v[70:71], v[70:71], v[134:135]
    v_pk_add_f32 v[48:49], v[48:49], 1.0 op_sel_hi:[1,0]
    v_pk_add_f32 v[50:51], v[50:51], 1.0 op_sel_hi:[1,0]
    v_pk_add_f32 v[52:53], v[52:53], 1.0 op_sel_hi:[1,0]
    v_pk_add_f32 v[54:55], v[54:55], 1.0 op_sel_hi:[1,0]
    v_rcp_f32 v48, v48
    v_rcp_f32 v49, v49
    v_rcp_f32 v50, v50
    v_rcp_f32 v51, v51
    v_rcp_f32 v52, v52
    v_rcp_f32 v53, v53
    v_rcp_f32 v54, v54
    v_rcp_f32 v55, v55
    v_pk_fma_f32 v[64:65], v[64:65], v[48:49], v[32:33]
    v_pk_fma_f32 v[66:67], v[66:67], v[50:51], v[34:35]
    v_cvt_pk_bf16_f32 v16, v64, v65
    v_cvt_pk_bf16_f32 v17, v66, v67
    buffer_store_dwordx2 v[16:17], v3, s[56:59], s8 offen offset:0
    s_nop 0
    v_pk_fma_f32 v[68:69], v[68:69], v[52:53], v[36:37]
    v_pk_fma_f32 v[70:71], v[70:71], v[54:55], v[38:39]
    v_cvt_pk_bf16_f32 v18, v68, v69
    v_cvt_pk_bf16_f32 v19, v70, v71
    buffer_store_dwordx2 v[18:19], v3, s[56:59], s8 offen offset:16
    s_endpgm
k_dft:
    s_add_u32 m0, s70, 16384
    s_lshl_b32 s72, s67, 7
    s_add_u32 s72, s72, s68
    buffer_load_dwordx4 v20, s[40:43], s72 offen lds
    buffer_load_dwordx4 v21, s[40:43], s72 offen offset:1024 lds
    s_add_u32 m0, s70, 81920
    s_mul_i32 s73, s67, 57344
    s_add_u32 s73, s73, s69
    buffer_load_dwordx4 v22, s[44:47], s73 offen lds
    buffer_load_dwordx4 v23, s[44:47], s73 offen offset:1024 lds
    s_add_u32 m0, s70, 98304
    s_add_u32 s67, s67, 1
    buffer_load_dwordx4 v22, s[48:51], s73 offen lds
    buffer_load_dwordx4 v23, s[48:51], s73 offen offset:1024 lds
    s_cmp_eq_u32 s67, 7
    s_cselect_b32 s67, 0, s67
    s_mov_b32 s52, s38
    s_and_b32 s53, s39, 0xffff
    s_mov_b32 s54, 268435456
    s_mov_b32 s55, 0x20000
    s_mov_b32 s4, s36
    s_and_b32 s5, s37, 0xffff
    s_mov_b32 s6, 256
    s_mov_b32 s7, 0x20000
    s_lshr_b32 s77, s60, 2
    s_and_b32 s78, s60, 3
    v_and_b32 v4, 31, v1
    v_lshrrev_b32 v0, 5, v1
    v_bfe_u32 v7, v1, 1, 3
    v_xor_b32 v7, v7, v0
    s_lshl_b32 s71, s78, 1
    v_xor_b32 v7, s71, v7
    v_lshlrev_b32 v7, 4, v7
    v_lshl_add_u32 v7, v4, 7, v7
    s_lshl_b32 s71, s77, 13
    v_add_u32 v8, s71, v7
    v_xor_b32 v9, 32, v8
    v_xor_b32 v10, 64, v8
    v_xor_b32 v11, 96, v8
    v_lshrrev_b32 v7, 2, v5
    v_lshl_add_u32 v6, v0, 3, v7
    v_lshlrev_b32 v6, 8, v6
    v_xor_b32 v7, s78, v7
    v_lshl_add_u32 v6, v7, 6, v6
    v_and_b32 v7, 1, v3
    v_lshl_add_u32 v6, v7, 5, v6
    v_and_b32 v7, 3, v1
    v_lshl_add_u32 v6, v7, 3, v6
    s_lshl_b32 s71, s78, 12
    s_add_u32 s71, s71, 49152
    v_add_u32 v12, s71, v6
    v_xor_b32 v13, 4096, v12
    v_xor_b32 v14, 8192, v12
    v_xor_b32 v15, 12288, v12
    v_add_u32 v16, 0x10000, v12
    v_add_u32 v17, 0x10000, v13
    v_add_u32 v18, 0x10000, v14
    v_add_u32 v19, 0x10000, v15
    v_mov_b32 v24, 0
    v_mov_b32 v25, 0
    v_mov_b32 v26, 0
    v_mov_b32 v27, 0
    s_cmp_gt_u32 s60, 1
    s_cbranch_scc1 kd_sd
    s_cmp_eq_u32 s60, 1
    s_cbranch_scc1 kd_sn
    v_mov_b32 v248, 0
    v_mov_b32 v249, 0
    v_mov_b32 v250, 0
    v_mov_b32 v251, 0
    s_lshl_b32 s71, s61, 4
    s_add_u32 s71, s71, s62
    s_lshl_b32 s71, s71, 10
    s_add_u32 s71, s71, 9437184
    buffer_store_dwordx4 v[248:251], v2, s[52:55], s71 offen sc0 sc1
    s_branch kd_sd
kd_sn:
    s_cmp_lg_u32 s2, 0
    s_cbranch_scc1 kd_sd
    s_or_b32 s98, s98, 1
    v_mov_b32 v248, s98
    v_mov_b32 v249, s99
    v_mov_b32 v250, 0
    s_mov_b64 exec, 1
    buffer_store_dwordx2 v[248:249], v250, s[4:7], 0 offen sc0 sc1
    s_mov_b64 exec, -1
kd_sd:
    v_cvt_f32_u32 v28, v4
    v_mul_f32 v28, 0x3d000000, v28
    v_cvt_f32_u32 v29, v0
    v_mul_f32 v29, 4.0, v29
    v_mul_f32 v29, v29, v28
    v_fmamk_f32 v32, v28, 0x00000000, v29
    v_fmamk_f32 v33, v28, 0x3f800000, v29
    v_cos_f32 v34, v32
    v_cos_f32 v35, v33
    v_sin_f32 v32, v32
    v_sin_f32 v33, v33
    v_cvt_pk_bf16_f32 v128, v34, v35
    v_cvt_pk_bf16_f32 v144, v32, v33
    v_cvt_pk_bf16_f32 v136, -v32, -v33
    v_fmamk_f32 v32, v28, 0x40000000, v29
    v_fmamk_f32 v33, v28, 0x40400000, v29
    v_cos_f32 v34, v32
    v_cos_f32 v35, v33
    v_sin_f32 v32, v32
    v_sin_f32 v33, v33
    v_cvt_pk_bf16_f32 v129, v34, v35
    v_cvt_pk_bf16_f32 v145, v32, v33
    v_cvt_pk_bf16_f32 v137, -v32, -v33
    v_fmamk_f32 v32, v28, 0x41000000, v29
    v_fmamk_f32 v33, v28, 0x41100000, v29
    v_cos_f32 v34, v32
    v_cos_f32 v35, v33
    v_sin_f32 v32, v32
    v_sin_f32 v33, v33
    v_cvt_pk_bf16_f32 v130, v34, v35
    v_cvt_pk_bf16_f32 v146, v32, v33
    v_cvt_pk_bf16_f32 v138, -v32, -v33
    v_fmamk_f32 v32, v28, 0x41200000, v29
    v_fmamk_f32 v33, v28, 0x41300000, v29
    v_cos_f32 v34, v32
    v_cos_f32 v35, v33
    v_sin_f32 v32, v32
    v_sin_f32 v33, v33
    v_cvt_pk_bf16_f32 v131, v34, v35
    v_cvt_pk_bf16_f32 v147, v32, v33
    v_cvt_pk_bf16_f32 v139, -v32, -v33
    v_fmamk_f32 v32, v28, 0x41800000, v29
    v_fmamk_f32 v33, v28, 0x41880000, v29
    v_cos_f32 v34, v32
    v_cos_f32 v35, v33
    v_sin_f32 v32, v32
    v_sin_f32 v33, v33
    v_cvt_pk_bf16_f32 v132, v34, v35
    v_cvt_pk_bf16_f32 v148, v32, v33
    v_cvt_pk_bf16_f32 v140, -v32, -v33
    v_fmamk_f32 v32, v28, 0x41900000, v29
    v_fmamk_f32 v33, v28, 0x41980000, v29
    v_cos_f32 v34, v32
    v_cos_f32 v35, v33
    v_sin_f32 v32, v32
    v_sin_f32 v33, v33
    v_cvt_pk_bf16_f32 v133, v34, v35
    v_cvt_pk_bf16_f32 v149, v32, v33
    v_cvt_pk_bf16_f32 v141, -v32, -v33
    v_fmamk_f32 v32, v28, 0x41c00000, v29
    v_fmamk_f32 v33, v28, 0x41c80000, v29
    v_cos_f32 v34, v32
    v_cos_f32 v35, v33
    v_sin_f32 v32, v32
    v_sin_f32 v33, v33
    v_cvt_pk_bf16_f32 v134, v34, v35
    v_cvt_pk_bf16_f32 v150, v32, v33
    v_cvt_pk_bf16_f32 v142, -v32, -v33
    v_fmamk_f32 v32, v28, 0x41d00000, v29
    v_fmamk_f32 v33, v28, 0x41d80000, v29
    v_cos_f32 v34, v32
    v_cos_f32 v35, v33
    v_sin_f32 v32, v32
    v_sin_f32 v33, v33
    v_cvt_pk_bf16_f32 v135, v34, v35
    v_cvt_pk_bf16_f32 v151, v32, v33
    v_cvt_pk_bf16_f32 v143, -v32, -v33
    s_lshl_b32 s74, s77, 11
    s_add_u32 s74, s74, 147456
    s_lshl_b32 s71, s78, 3
    s_add_u32 s71, s71, s74
    v_lshl_add_u32 v5, v1, 5, s71
    v_lshl_add_u32 v6, v1, 5, s74
    s_lshl_b32 s71, s60, 8
    s_add_u32 s71, s71, 155648
    v_lshl_add_u32 v7, v1, 2, s71
    v_lshl_add_u32 v3, v0, 4, s71
    s_waitcnt vmcnt(6)
    s_barrier
    ds_read_b128 v[32:35], v8 offset:0
    ds_read_b64_tr_b16 v[40:41], v12 offset:0
    ds_read_b64_tr_b16 v[42:43], v12 offset:1024
    ds_read_b64_tr_b16 v[44:45], v12 offset:16384
    ds_read_b64_tr_b16 v[46:47], v12 offset:17408
    ds_read_b128 v[36:39], v8 offset:4096
    s_waitcnt lgkmcnt(3)
    v_mfma_f32_32x32x16_bf16 v[64:79], v[32:35], v[40:43], 0
    ds_read_b128 v[48:51], v9 offset:0
    ds_read_b64_tr_b16 v[56:57], v13 offset:0
    v_lshlrev_b32 v28, 16, v32
    v_and_b32 v29, s76, v32
    v_add_f32 v24, v24, v28
    s_waitcnt lgkmcnt(3)
    v_mfma_f32_32x32x16_bf16 v[80:95], v[32:35], v[44:47], 0
    ds_read_b64_tr_b16 v[58:59], v13 offset:1024
    ds_read_b64_tr_b16 v[60:61], v13 offset:16384
    v_fmac_f32 v26, v28, v28
    v_add_f32 v24, v24, v29
    v_fmac_f32 v26, v29, v29
    s_waitcnt lgkmcnt(4)
    v_mfma_f32_32x32x16_bf16 v[96:111], v[36:39], v[40:43], 0
    ds_read_b64_tr_b16 v[62:63], v13 offset:17408
    ds_read_b128 v[52:55], v9 offset:4096
    v_lshlrev_b32 v28, 16, v33
    v_and_b32 v29, s76, v33
    v_add_f32 v24, v24, v28
    s_add_u32 m0, s70, 32768
    s_lshl_b32 s72, s67, 7
    s_add_u32 s72, s72, s68
    buffer_load_dwordx4 v20, s[40:43], s72 offen lds
    v_mfma_f32_32x32x16_bf16 v[112:127], v[36:39], v[44:47], 0
    v_fmac_f32 v26, v28, v28
    v_add_f32 v24, v24, v29
    v_fmac_f32 v26, v29, v29
    buffer_load_dwordx4 v21, s[40:43], s72 offen offset:1024 lds
    s_waitcnt lgkmcnt(3)
    v_mfma_f32_32x32x16_bf16 v[64:79], v[48:51], v[56:59], v[64:79]
    ds_read_b128 v[32:35], v10 offset:0
    ds_read_b64_tr_b16 v[40:41], v14 offset:0
    s_waitcnt lgkmcnt(2)
    v_mfma_f32_32x32x16_bf16 v[80:95], v[48:51], v[60:63], v[80:95]
    ds_read_b64_tr_b16 v[42:43], v14 offset:1024
    ds_read_b64_tr_b16 v[44:45], v14 offset:16384
    v_lshlrev_b32 v28, 16, v52
    v_and_b32 v29, s76, v52
    v_add_f32 v25, v25, v28
    v_fmac_f32 v27, v28, v28
    v_mfma_f32_32x32x16_bf16 v[96:111], v[52:55], v[56:59], v[96:111]
    ds_read_b64_tr_b16 v[46:47], v14 offset:17408
    ds_read_b128 v[36:39], v10 offset:4096
    v_add_f32 v25, v25, v29
    v_fmac_f32 v27, v29, v29
    v_lshlrev_b32 v28, 16, v53
    v_and_b32 v29, s76, v53
    s_add_u32 m0, s70, 114688
    s_mul_i32 s73, s67, 57344
    s_add_u32 s73, s73, s69
    buffer_load_dwordx4 v22, s[44:47], s73 offen lds
    v_mfma_f32_32x32x16_bf16 v[112:127], v[52:55], v[60:63], v[112:127]
    v_add_f32 v25, v25, v28
    v_fmac_f32 v27, v28, v28
    v_add_f32 v25, v25, v29
    v_fmac_f32 v27, v29, v29
    buffer_load_dwordx4 v23, s[44:47], s73 offen offset:1024 lds
    s_waitcnt lgkmcnt(3)
    v_mfma_f32_32x32x16_bf16 v[64:79], v[32:35], v[40:43], v[64:79]
    ds_read_b128 v[48:51], v11 offset:0
    ds_read_b64_tr_b16 v[56:57], v15 offset:0
    v_lshlrev_b32 v28, 16, v34
    v_and_b32 v29, s76, v34
    v_add_f32 v24, v24, v28
    s_waitcnt lgkmcnt(3)
    v_mfma_f32_32x32x16_bf16 v[80:95], v[32:35], v[44:47], v[80:95]
    ds_read_b64_tr_b16 v[58:59], v15 offset:1024
    ds_read_b64_tr_b16 v[60:61], v15 offset:16384
    v_fmac_f32 v26, v28, v28
    v_add_f32 v24, v24, v29
    v_fmac_f32 v26, v29, v29
    s_waitcnt lgkmcnt(4)
    v_mfma_f32_32x32x16_bf16 v[96:111], v[36:39], v[40:43], v[96:111]
    ds_read_b64_tr_b16 v[62:63], v15 offset:17408
    ds_read_b128 v[52:55], v11 offset:4096
    v_lshlrev_b32 v28, 16, v35
    v_and_b32 v29, s76, v35
    v_add_f32 v24, v24, v28
    s_add_u32 m0, s70, 131072
    s_add_u32 s67, s67, 1
    buffer_load_dwordx4 v22, s[48:51], s73 offen lds
    v_mfma_f32_32x32x16_bf16 v[112:127], v[36:39], v[44:47], v[112:127]
    v_fmac_f32 v26, v28, v28
    v_add_f32 v24, v24, v29
    v_fmac_f32 v26, v29, v29
    buffer_load_dwordx4 v23, s[48:51], s73 offen offset:1024 lds
    s_cmp_eq_u32 s67, 7
    s_cselect_b32 s67, 0, s67
    s_waitcnt vmcnt(6) lgkmcnt(0)
    s_barrier
    v_mfma_f32_32x32x16_bf16 v[64:79], v[48:51], v[56:59], v[64:79]
    ds_read_b128 v[32:35], v8 offset:16384
    ds_read_b64_tr_b16 v[40:41], v12 offset:32768
    v_mfma_f32_32x32x16_bf16 v[80:95], v[48:51], v[60:63], v[80:95]
    ds_read_b64_tr_b16 v[42:43], v12 offset:33792
    ds_read_b64_tr_b16 v[44:45], v12 offset:49152
    v_lshlrev_b32 v28, 16, v54
    v_and_b32 v29, s76, v54
    v_add_f32 v25, v25, v28
    v_fmac_f32 v27, v28, v28
    v_mfma_f32_32x32x16_bf16 v[96:111], v[52:55], v[56:59], v[96:111]
    ds_read_b64_tr_b16 v[46:47], v12 offset:50176
    ds_read_b128 v[36:39], v8 offset:20480
    v_add_f32 v25, v25, v29
    v_fmac_f32 v27, v29, v29
    v_lshlrev_b32 v28, 16, v55
    v_and_b32 v29, s76, v55
    s_add_u32 m0, s70, 0
    s_lshl_b32 s72, s67, 7
    s_add_u32 s72, s72, s68
    buffer_load_dwordx4 v20, s[40:43], s72 offen lds
    v_mfma_f32_32x32x16_bf16 v[112:127], v[52:55], v[60:63], v[112:127]
    v_add_f32 v25, v25, v28
    v_fmac_f32 v27, v28, v28
    v_add_f32 v25, v25, v29
    v_fmac_f32 v27, v29, v29
    buffer_load_dwordx4 v21, s[40:43], s72 offen offset:1024 lds
    s_waitcnt lgkmcnt(3)
    v_mfma_f32_32x32x16_bf16 v[64:79], v[32:35], v[40:43], v[64:79]
    ds_read_b128 v[48:51], v9 offset:16384
    ds_read_b64_tr_b16 v[56:57], v13 offset:32768
    v_lshlrev_b32 v28, 16, v32
    v_and_b32 v29, s76, v32
    v_add_f32 v24, v24, v28
    s_waitcnt lgkmcnt(3)
    v_mfma_f32_32x32x16_bf16 v[80:95], v[32:35], v[44:47], v[80:95]
    ds_read_b64_tr_b16 v[58:59], v13 offset:33792
    ds_read_b64_tr_b16 v[60:61], v13 offset:49152
    v_fmac_f32 v26, v28, v28
    v_add_f32 v24, v24, v29
    v_fmac_f32 v26, v29, v29
    s_waitcnt lgkmcnt(4)
    v_mfma_f32_32x32x16_bf16 v[96:111], v[36:39], v[40:43], v[96:111]
    ds_read_b64_tr_b16 v[62:63], v13 offset:50176
    ds_read_b128 v[52:55], v9 offset:20480
    v_lshlrev_b32 v28, 16, v33
    v_and_b32 v29, s76, v33
    v_add_f32 v24, v24, v28
    s_add_u32 m0, s70, 49152
    s_mul_i32 s73, s67, 57344
    s_add_u32 s73, s73, s69
    buffer_load_dwordx4 v22, s[44:47], s73 offen lds
    v_mfma_f32_32x32x16_bf16 v[112:127], v[36:39], v[44:47], v[112:127]
    v_fmac_f32 v26, v28, v28
    v_add_f32 v24, v24, v29
    v_fmac_f32 v26, v29, v29
    buffer_load_dwordx4 v23, s[44:47], s73 offen offset:1024 lds
    s_waitcnt lgkmcnt(3)
    v_mfma_f32_32x32x16_bf16 v[64:79], v[48:51], v[56:59], v[64:79]
    ds_read_b128 v[32:35], v10 offset:16384
    ds_read_b64_tr_b16 v[40:41], v14 offset:32768
    s_waitcnt lgkmcnt(2)
    v_mfma_f32_32x32x16_bf16 v[80:95], v[48:51], v[60:63], v[80:95]
    ds_read_b64_tr_b16 v[42:43], v14 offset:33792
    ds_read_b64_tr_b16 v[44:45], v14 offset:49152
    v_lshlrev_b32 v28, 16, v52
    v_and_b32 v29, s76, v52
    v_add_f32 v25, v25, v28
    v_fmac_f32 v27, v28, v28
    v_mfma_f32_32x32x16_bf16 v[96:111], v[52:55], v[56:59], v[96:111]
    ds_read_b64_tr_b16 v[46:47], v14 offset:50176
    ds_read_b128 v[36:39], v10 offset:20480
    v_add_f32 v25, v25, v29
    v_fmac_f32 v27, v29, v29
    v_lshlrev_b32 v28, 16, v53
    v_and_b32 v29, s76, v53
    s_add_u32 m0, s70, 65536
    s_add_u32 s67, s67, 1
    buffer_load_dwordx4 v22, s[48:51], s73 offen lds
    v_mfma_f32_32x32x16_bf16 v[112:127], v[52:55], v[60:63], v[112:127]
    v_add_f32 v25, v25, v28
    v_fmac_f32 v27, v28, v28
    v_add_f32 v25, v25, v29
    v_fmac_f32 v27, v29, v29
    buffer_load_dwordx4 v23, s[48:51], s73 offen offset:1024 lds
    s_cmp_eq_u32 s67, 7
    s_cselect_b32 s67, 0, s67
    s_waitcnt lgkmcnt(3)
    v_mfma_f32_32x32x16_bf16 v[64:79], v[32:35], v[40:43], v[64:79]
    ds_read_b128 v[48:51], v11 offset:16384
    ds_read_b64_tr_b16 v[56:57], v15 offset:32768
    v_lshlrev_b32 v28, 16, v34
    v_and_b32 v29, s76, v34
    v_add_f32 v24, v24, v28
    s_waitcnt lgkmcnt(3)
    v_mfma_f32_32x32x16_bf16 v[80:95], v[32:35], v[44:47], v[80:95]
    ds_read_b64_tr_b16 v[58:59], v15 offset:33792
    ds_read_b64_tr_b16 v[60:61], v15 offset:49152
    v_fmac_f32 v26, v28, v28
    v_add_f32 v24, v24, v29
    v_fmac_f32 v26, v29, v29
    s_waitcnt lgkmcnt(4)
    v_mfma_f32_32x32x16_bf16 v[96:111], v[36:39], v[40:43], v[96:111]
    ds_read_b64_tr_b16 v[62:63], v15 offset:50176
    ds_read_b128 v[52:55], v11 offset:20480
    v_lshlrev_b32 v28, 16, v35
    v_and_b32 v29, s76, v35
    v_add_f32 v24, v24, v28
    v_mfma_f32_32x32x16_bf16 v[112:127], v[36:39], v[44:47], v[112:127]
    v_fmac_f32 v26, v28, v28
    v_add_f32 v24, v24, v29
    v_fmac_f32 v26, v29, v29
    s_waitcnt vmcnt(6) lgkmcnt(0)
    s_barrier
    v_mfma_f32_32x32x16_bf16 v[64:79], v[48:51], v[56:59], v[64:79]
    ds_read_b128 v[32:35], v8 offset:32768
    ds_read_b64_tr_b16 v[40:41], v16 offset:0
    v_mfma_f32_32x32x16_bf16 v[80:95], v[48:51], v[60:63], v[80:95]
    ds_read_b64_tr_b16 v[42:43], v16 offset:1024
    ds_read_b64_tr_b16 v[44:45], v16 offset:16384
    v_lshlrev_b32 v28, 16, v54
    v_and_b32 v29, s76, v54
    v_add_f32 v25, v25, v28
    v_fmac_f32 v27, v28, v28
    v_mfma_f32_32x32x16_bf16 v[96:111], v[52:55], v[56:59], v[96:111]
    ds_read_b64_tr_b16 v[46:47], v16 offset:17408
    ds_read_b128 v[36:39], v8 offset:36864
    v_add_f32 v25, v25, v29
    v_fmac_f32 v27, v29, v29
    v_lshlrev_b32 v28, 16, v55
    v_and_b32 v29, s76, v55
    s_add_u32 m0, s70, 16384
    s_lshl_b32 s72, s67, 7
    s_add_u32 s72, s72, s68
    buffer_load_dwordx4 v20, s[40:43], s72 offen lds
    v_mfma_f32_32x32x16_bf16 v[112:127], v[52:55], v[60:63], v[112:127]
    v_add_f32 v25, v25, v28
    v_fmac_f32 v27, v28, v28
    v_add_f32 v25, v25, v29
    v_fmac_f32 v27, v29, v29
    buffer_load_dwordx4 v21, s[40:43], s72 offen offset:1024 lds
    s_waitcnt lgkmcnt(3)
    v_mfma_f32_32x32x16_bf16 v[64:79], v[32:35], v[40:43], v[64:79]
    ds_read_b128 v[48:51], v9 offset:32768
    ds_read_b64_tr_b16 v[56:57], v17 offset:0
    v_lshlrev_b32 v28, 16, v32
    v_and_b32 v29, s76, v32
    v_add_f32 v24, v24, v28
    s_waitcnt lgkmcnt(3)
    v_mfma_f32_32x32x16_bf16 v[80:95], v[32:35], v[44:47], v[80:95]
    ds_read_b64_tr_b16 v[58:59], v17 offset:1024
    ds_read_b64_tr_b16 v[60:61], v17 offset:16384
    v_fmac_f32 v26, v28, v28
    v_add_f32 v24, v24, v29
    v_fmac_f32 v26, v29, v29
    s_waitcnt lgkmcnt(4)
    v_mfma_f32_32x32x16_bf16 v[96:111], v[36:39], v[40:43], v[96:111]
    ds_read_b64_tr_b16 v[62:63], v17 offset:17408
    ds_read_b128 v[52:55], v9 offset:36864
    v_lshlrev_b32 v28, 16, v33
    v_and_b32 v29, s76, v33
    v_add_f32 v24, v24, v28
    s_add_u32 m0, s70, 81920
    s_mul_i32 s73, s67, 57344
    s_add_u32 s73, s73, s69
    buffer_load_dwordx4 v22, s[44:47], s73 offen lds
    v_mfma_f32_32x32x16_bf16 v[112:127], v[36:39], v[44:47], v[112:127]
    v_fmac_f32 v26, v28, v28
    v_add_f32 v24, v24, v29
    v_fmac_f32 v26, v29, v29
    buffer_load_dwordx4 v23, s[44:47], s73 offen offset:1024 lds
    s_waitcnt lgkmcnt(3)
    v_mfma_f32_32x32x16_bf16 v[64:79], v[48:51], v[56:59], v[64:79]
    ds_read_b128 v[32:35], v10 offset:32768
    ds_read_b64_tr_b16 v[40:41], v18 offset:0
    s_waitcnt lgkmcnt(2)
    v_mfma_f32_32x32x16_bf16 v[80:95], v[48:51], v[60:63], v[80:95]
    ds_read_b64_tr_b16 v[42:43], v18 offset:1024
    ds_read_b64_tr_b16 v[44:45], v18 offset:16384
    v_lshlrev_b32 v28, 16, v52
    v_and_b32 v29, s76, v52
    v_add_f32 v25, v25, v28
    v_fmac_f32 v27, v28, v28
    v_mfma_f32_32x32x16_bf16 v[96:111], v[52:55], v[56:59], v[96:111]
    ds_read_b64_tr_b16 v[46:47], v18 offset:17408
    ds_read_b128 v[36:39], v10 offset:36864
    v_add_f32 v25, v25, v29
    v_fmac_f32 v27, v29, v29
    v_lshlrev_b32 v28, 16, v53
    v_and_b32 v29, s76, v53
    s_add_u32 m0, s70, 98304
    s_add_u32 s67, s67, 1
    buffer_load_dwordx4 v22, s[48:51], s73 offen lds
    v_mfma_f32_32x32x16_bf16 v[112:127], v[52:55], v[60:63], v[112:127]
    v_add_f32 v25, v25, v28
    v_fmac_f32 v27, v28, v28
    v_add_f32 v25, v25, v29
    v_fmac_f32 v27, v29, v29
    buffer_load_dwordx4 v23, s[48:51], s73 offen offset:1024 lds
    s_cmp_eq_u32 s67, 7
    s_cselect_b32 s67, 0, s67
    s_waitcnt lgkmcnt(3)
    v_mfma_f32_32x32x16_bf16 v[64:79], v[32:35], v[40:43], v[64:79]
    ds_read_b128 v[48:51], v11 offset:32768
    ds_read_b64_tr_b16 v[56:57], v19 offset:0
    v_lshlrev_b32 v28, 16, v34
    v_and_b32 v29, s76, v34
    v_add_f32 v24, v24, v28
    s_waitcnt lgkmcnt(3)
    v_mfma_f32_32x32x16_bf16 v[80:95], v[32:35], v[44:47], v[80:95]
    ds_read_b64_tr_b16 v[58:59], v19 offset:1024
    ds_read_b64_tr_b16 v[60:61], v19 offset:16384
    v_fmac_f32 v26, v28, v28
    v_add_f32 v24, v24, v29
    v_fmac_f32 v26, v29, v29
    s_waitcnt lgkmcnt(4)
    v_mfma_f32_32x32x16_bf16 v[96:111], v[36:39], v[40:43], v[96:111]
    ds_read_b64_tr_b16 v[62:63], v19 offset:17408
    ds_read_b128 v[52:55], v11 offset:36864
    v_lshlrev_b32 v28, 16, v35
    v_and_b32 v29, s76, v35
    v_add_f32 v24, v24, v28
    v_mfma_f32_32x32x16_bf16 v[112:127], v[36:39], v[44:47], v[112:127]
    v_fmac_f32 v26, v28, v28
    v_add_f32 v24, v24, v29
    v_fmac_f32 v26, v29, v29
    s_waitcnt vmcnt(6) lgkmcnt(0)
    s_barrier
    v_mfma_f32_32x32x16_bf16 v[64:79], v[48:51], v[56:59], v[64:79]
    ds_read_b128 v[32:35], v8 offset:0
    ds_read_b64_tr_b16 v[40:41], v12 offset:0
    v_mfma_f32_32x32x16_bf16 v[80:95], v[48:51], v[60:63], v[80:95]
    ds_read_b64_tr_b16 v[42:43], v12 offset:1024
    ds_read_b64_tr_b16 v[44:45], v12 offset:16384
    v_lshlrev_b32 v28, 16, v54
    v_and_b32 v29, s76, v54
    v_add_f32 v25, v25, v28
    v_fmac_f32 v27, v28, v28
    v_mfma_f32_32x32x16_bf16 v[96:111], v[52:55], v[56:59], v[96:111]
    ds_read_b64_tr_b16 v[46:47], v12 offset:17408
    ds_read_b128 v[36:39], v8 offset:4096
    v_add_f32 v25, v25, v29
    v_fmac_f32 v27, v29, v29
    v_lshlrev_b32 v28, 16, v55
    v_and_b32 v29, s76, v55
    s_add_u32 m0, s70, 32768
    s_lshl_b32 s72, s67, 7
    s_add_u32 s72, s72, s68
    buffer_load_dwordx4 v20, s[40:43], s72 offen lds
    v_mfma_f32_32x32x16_bf16 v[112:127], v[52:55], v[60:63], v[112:127]
    v_add_f32 v25, v25, v28
    v_fmac_f32 v27, v28, v28
    v_add_f32 v25, v25, v29
    v_fmac_f32 v27, v29, v29
    buffer_load_dwordx4 v21, s[40:43], s72 offen offset:1024 lds
    s_waitcnt lgkmcnt(3)
    v_mfma_f32_32x32x16_bf16 v[64:79], v[32:35], v[40:43], v[64:79]
    ds_read_b128 v[48:51], v9 offset:0
    ds_read_b64_tr_b16 v[56:57], v13 offset:0
    v_lshlrev_b32 v28, 16, v32
    v_and_b32 v29, s76, v32
    v_add_f32 v24, v24, v28
    s_waitcnt lgkmcnt(3)
    v_mfma_f32_32x32x16_bf16 v[80:95], v[32:35], v[44:47], v[80:95]
    ds_read_b64_tr_b16 v[58:59], v13 offset:1024
    ds_read_b64_tr_b16 v[60:61], v13 offset:16384
    v_fmac_f32 v26, v28, v28
    v_add_f32 v24, v24, v29
    v_fmac_f32 v26, v29, v29
    s_waitcnt lgkmcnt(4)
    v_mfma_f32_32x32x16_bf16 v[96:111], v[36:39], v[40:43], v[96:111]
    ds_read_b64_tr_b16 v[62:63], v13 offset:17408
    ds_read_b128 v[52:55], v9 offset:4096
    v_lshlrev_b32 v28, 16, v33
    v_and_b32 v29, s76, v33
    v_add_f32 v24, v24, v28
    s_add_u32 m0, s70, 114688
    s_mul_i32 s73, s67, 57344
    s_add_u32 s73, s73, s69
    buffer_load_dwordx4 v22, s[44:47], s73 offen lds
    v_mfma_f32_32x32x16_bf16 v[112:127], v[36:39], v[44:47], v[112:127]
    v_fmac_f32 v26, v28, v28
    v_add_f32 v24, v24, v29
    v_fmac_f32 v26, v29, v29
    buffer_load_dwordx4 v23, s[44:47], s73 offen offset:1024 lds
    s_waitcnt lgkmcnt(3)
    v_mfma_f32_32x32x16_bf16 v[64:79], v[48:51], v[56:59], v[64:79]
    ds_read_b128 v[32:35], v10 offset:0
    ds_read_b64_tr_b16 v[40:41], v14 offset:0
    s_waitcnt lgkmcnt(2)
    v_mfma_f32_32x32x16_bf16 v[80:95], v[48:51], v[60:63], v[80:95]
    ds_read_b64_tr_b16 v[42:43], v14 offset:1024
    ds_read_b64_tr_b16 v[44:45], v14 offset:16384
    v_lshlrev_b32 v28, 16, v52
    v_and_b32 v29, s76, v52
    v_add_f32 v25, v25, v28
    v_fmac_f32 v27, v28, v28
    v_mfma_f32_32x32x16_bf16 v[96:111], v[52:55], v[56:59], v[96:111]
    ds_read_b64_tr_b16 v[46:47], v14 offset:17408
    ds_read_b128 v[36:39], v10 offset:4096
    v_add_f32 v25, v25, v29
    v_fmac_f32 v27, v29, v29
    v_lshlrev_b32 v28, 16, v53
    v_and_b32 v29, s76, v53
    s_add_u32 m0, s70, 131072
    s_add_u32 s67, s67, 1
    buffer_load_dwordx4 v22, s[48:51], s73 offen lds
    v_mfma_f32_32x32x16_bf16 v[112:127], v[52:55], v[60:63], v[112:127]
    v_add_f32 v25, v25, v28
    v_fmac_f32 v27, v28, v28
    v_add_f32 v25, v25, v29
    v_fmac_f32 v27, v29, v29
    buffer_load_dwordx4 v23, s[48:51], s73 offen offset:1024 lds
    s_cmp_eq_u32 s67, 7
    s_cselect_b32 s67, 0, s67
    s_waitcnt lgkmcnt(3)
    v_mfma_f32_32x32x16_bf16 v[64:79], v[32:35], v[40:43], v[64:79]
    ds_read_b128 v[48:51], v11 offset:0
    ds_read_b64_tr_b16 v[56:57], v15 offset:0
    v_lshlrev_b32 v28, 16, v34
    v_and_b32 v29, s76, v34
    v_add_f32 v24, v24, v28
    s_waitcnt lgkmcnt(3)
    v_mfma_f32_32x32x16_bf16 v[80:95], v[32:35], v[44:47], v[80:95]
    ds_read_b64_tr_b16 v[58:59], v15 offset:1024
    ds_read_b64_tr_b16 v[60:61], v15 offset:16384
    v_fmac_f32 v26, v28, v28
    v_add_f32 v24, v24, v29
    v_fmac_f32 v26, v29, v29
    s_waitcnt lgkmcnt(4)
    v_mfma_f32_32x32x16_bf16 v[96:111], v[36:39], v[40:43], v[96:111]
    ds_read_b64_tr_b16 v[62:63], v15 offset:17408
    ds_read_b128 v[52:55], v11 offset:4096
    v_lshlrev_b32 v28, 16, v35
    v_and_b32 v29, s76, v35
    v_add_f32 v24, v24, v28
    v_mfma_f32_32x32x16_bf16 v[112:127], v[36:39], v[44:47], v[112:127]
    v_fmac_f32 v26, v28, v28
    v_add_f32 v24, v24, v29
    v_fmac_f32 v26, v29, v29
    s_waitcnt vmcnt(6) lgkmcnt(0)
    s_barrier
    v_mfma_f32_32x32x16_bf16 v[64:79], v[48:51], v[56:59], v[64:79]
    ds_read_b128 v[32:35], v8 offset:16384
    ds_read_b64_tr_b16 v[40:41], v12 offset:32768
    v_mfma_f32_32x32x16_bf16 v[80:95], v[48:51], v[60:63], v[80:95]
    ds_read_b64_tr_b16 v[42:43], v12 offset:33792
    ds_read_b64_tr_b16 v[44:45], v12 offset:49152
    v_lshlrev_b32 v28, 16, v54
    v_and_b32 v29, s76, v54
    v_add_f32 v25, v25, v28
    v_fmac_f32 v27, v28, v28
    v_mfma_f32_32x32x16_bf16 v[96:111], v[52:55], v[56:59], v[96:111]
    ds_read_b64_tr_b16 v[46:47], v12 offset:50176
    ds_read_b128 v[36:39], v8 offset:20480
    v_add_f32 v25, v25, v29
    v_fmac_f32 v27, v29, v29
    v_lshlrev_b32 v28, 16, v55
    v_and_b32 v29, s76, v55
    s_add_u32 m0, s70, 0
    s_lshl_b32 s72, s67, 7
    s_add_u32 s72, s72, s68
    buffer_load_dwordx4 v20, s[40:43], s72 offen lds
    v_mfma_f32_32x32x16_bf16 v[112:127], v[52:55], v[60:63], v[112:127]
    v_add_f32 v25, v25, v28
    v_fmac_f32 v27, v28, v28
    v_add_f32 v25, v25, v29
    v_fmac_f32 v27, v29, v29
    buffer_load_dwordx4 v21, s[40:43], s72 offen offset:1024 lds
    s_waitcnt lgkmcnt(3)
    v_mfma_f32_32x32x16_bf16 v[64:79], v[32:35], v[40:43], v[64:79]
    ds_read_b128 v[48:51], v9 offset:16384
    ds_read_b64_tr_b16 v[56:57], v13 offset:32768
    v_lshlrev_b32 v28, 16, v32
    v_and_b32 v29, s76, v32
    v_add_f32 v24, v24, v28
    s_waitcnt lgkmcnt(3)
    v_mfma_f32_32x32x16_bf16 v[80:95], v[32:35], v[44:47], v[80:95]
    ds_read_b64_tr_b16 v[58:59], v13 offset:33792
    ds_read_b64_tr_b16 v[60:61], v13 offset:49152
    v_fmac_f32 v26, v28, v28
    v_add_f32 v24, v24, v29
    v_fmac_f32 v26, v29, v29
    s_waitcnt lgkmcnt(4)
    v_mfma_f32_32x32x16_bf16 v[96:111], v[36:39], v[40:43], v[96:111]
    ds_read_b64_tr_b16 v[62:63], v13 offset:50176
    ds_read_b128 v[52:55], v9 offset:20480
    v_lshlrev_b32 v28, 16, v33
    v_and_b32 v29, s76, v33
    v_add_f32 v24, v24, v28
    s_add_u32 m0, s70, 49152
    s_mul_i32 s73, s67, 57344
    s_add_u32 s73, s73, s69
    buffer_load_dwordx4 v22, s[44:47], s73 offen lds
    v_mfma_f32_32x32x16_bf16 v[112:127], v[36:39], v[44:47], v[112:127]
    v_fmac_f32 v26, v28, v28
    v_add_f32 v24, v24, v29
    v_fmac_f32 v26, v29, v29
    buffer_load_dwordx4 v23, s[44:47], s73 offen offset:1024 lds
    s_waitcnt lgkmcnt(3)
    v_mfma_f32_32x32x16_bf16 v[64:79], v[48:51], v[56:59], v[64:79]
    ds_read_b128 v[32:35], v10 offset:16384
    ds_read_b64_tr_b16 v[40:41], v14 offset:32768
    s_waitcnt lgkmcnt(2)
    v_mfma_f32_32x32x16_bf16 v[80:95], v[48:51], v[60:63], v[80:95]
    ds_read_b64_tr_b16 v[42:43], v14 offset:33792
    ds_read_b64_tr_b16 v[44:45], v14 offset:49152
    v_lshlrev_b32 v28, 16, v52
    v_and_b32 v29, s76, v52
    v_add_f32 v25, v25, v28
    v_fmac_f32 v27, v28, v28
    v_mfma_f32_32x32x16_bf16 v[96:111], v[52:55], v[56:59], v[96:111]
    ds_read_b64_tr_b16 v[46:47], v14 offset:50176
    ds_read_b128 v[36:39], v10 offset:20480
    v_add_f32 v25, v25, v29
    v_fmac_f32 v27, v29, v29
    v_lshlrev_b32 v28, 16, v53
    v_and_b32 v29, s76, v53
    s_add_u32 m0, s70, 65536
    s_add_u32 s67, s67, 1
    buffer_load_dwordx4 v22, s[48:51], s73 offen lds
    v_mfma_f32_32x32x16_bf16 v[112:127], v[52:55], v[60:63], v[112:127]
    v_add_f32 v25, v25, v28
    v_fmac_f32 v27, v28, v28
    v_add_f32 v25, v25, v29
    v_fmac_f32 v27, v29, v29
    buffer_load_dwordx4 v23, s[48:51], s73 offen offset:1024 lds
    s_cmp_eq_u32 s67, 7
    s_cselect_b32 s67, 0, s67
    s_waitcnt lgkmcnt(3)
    v_mfma_f32_32x32x16_bf16 v[64:79], v[32:35], v[40:43], v[64:79]
    ds_read_b128 v[48:51], v11 offset:16384
    ds_read_b64_tr_b16 v[56:57], v15 offset:32768
    v_lshlrev_b32 v28, 16, v34
    v_and_b32 v29, s76, v34
    v_add_f32 v24, v24, v28
    s_waitcnt lgkmcnt(3)
    v_mfma_f32_32x32x16_bf16 v[80:95], v[32:35], v[44:47], v[80:95]
    ds_read_b64_tr_b16 v[58:59], v15 offset:33792
    ds_read_b64_tr_b16 v[60:61], v15 offset:49152
    v_fmac_f32 v26, v28, v28
    v_add_f32 v24, v24, v29
    v_fmac_f32 v26, v29, v29
    s_waitcnt lgkmcnt(4)
    v_mfma_f32_32x32x16_bf16 v[96:111], v[36:39], v[40:43], v[96:111]
    ds_read_b64_tr_b16 v[62:63], v15 offset:50176
    ds_read_b128 v[52:55], v11 offset:20480
    v_lshlrev_b32 v28, 16, v35
    v_and_b32 v29, s76, v35
    v_add_f32 v24, v24, v28
    v_mfma_f32_32x32x16_bf16 v[112:127], v[36:39], v[44:47], v[112:127]
    v_fmac_f32 v26, v28, v28
    v_add_f32 v24, v24, v29
    v_fmac_f32 v26, v29, v29
    s_waitcnt vmcnt(6) lgkmcnt(0)
    s_barrier
    v_mfma_f32_32x32x16_bf16 v[64:79], v[48:51], v[56:59], v[64:79]
    ds_read_b128 v[32:35], v8 offset:32768
    ds_read_b64_tr_b16 v[40:41], v16 offset:0
    v_mfma_f32_32x32x16_bf16 v[80:95], v[48:51], v[60:63], v[80:95]
    ds_read_b64_tr_b16 v[42:43], v16 offset:1024
    ds_read_b64_tr_b16 v[44:45], v16 offset:16384
    v_lshlrev_b32 v28, 16, v54
    v_and_b32 v29, s76, v54
    v_add_f32 v25, v25, v28
    v_fmac_f32 v27, v28, v28
    v_mfma_f32_32x32x16_bf16 v[96:111], v[52:55], v[56:59], v[96:111]
    ds_read_b64_tr_b16 v[46:47], v16 offset:17408
    ds_read_b128 v[36:39], v8 offset:36864
    v_add_f32 v25, v25, v29
    v_fmac_f32 v27, v29, v29
    v_lshlrev_b32 v28, 16, v55
    v_and_b32 v29, s76, v55
    v_mfma_f32_32x32x16_bf16 v[112:127], v[52:55], v[60:63], v[112:127]
    v_add_f32 v25, v25, v28
    v_fmac_f32 v27, v28, v28
    v_add_f32 v25, v25, v29
    v_fmac_f32 v27, v29, v29
    s_waitcnt lgkmcnt(3)
    v_mfma_f32_32x32x16_bf16 v[64:79], v[32:35], v[40:43], v[64:79]
    ds_read_b128 v[48:51], v9 offset:32768
    ds_read_b64_tr_b16 v[56:57], v17 offset:0
    v_lshlrev_b32 v28, 16, v32
    v_and_b32 v29, s76, v32
    v_add_f32 v24, v24, v28
    s_waitcnt lgkmcnt(3)
    v_mfma_f32_32x32x16_bf16 v[80:95], v[32:35], v[44:47], v[80:95]
    ds_read_b64_tr_b16 v[58:59], v17 offset:1024
    ds_read_b64_tr_b16 v[60:61], v17 offset:16384
    v_fmac_f32 v26, v28, v28
    v_add_f32 v24, v24, v29
    v_fmac_f32 v26, v29, v29
    s_waitcnt lgkmcnt(4)
    v_mfma_f32_32x32x16_bf16 v[96:111], v[36:39], v[40:43], v[96:111]
    ds_read_b64_tr_b16 v[62:63], v17 offset:17408
    ds_read_b128 v[52:55], v9 offset:36864
    v_lshlrev_b32 v28, 16, v33
    v_and_b32 v29, s76, v33
    v_add_f32 v24, v24, v28
    v_mfma_f32_32x32x16_bf16 v[112:127], v[36:39], v[44:47], v[112:127]
    v_fmac_f32 v26, v28, v28
    v_add_f32 v24, v24, v29
    v_fmac_f32 v26, v29, v29
    s_waitcnt lgkmcnt(3)
    v_mfma_f32_32x32x16_bf16 v[64:79], v[48:51], v[56:59], v[64:79]
    ds_read_b128 v[32:35], v10 offset:32768
    ds_read_b64_tr_b16 v[40:41], v18 offset:0
    s_waitcnt lgkmcnt(2)
    v_mfma_f32_32x32x16_bf16 v[80:95], v[48:51], v[60:63], v[80:95]
    ds_read_b64_tr_b16 v[42:43], v18 offset:1024
    ds_read_b64_tr_b16 v[44:45], v18 offset:16384
    v_lshlrev_b32 v28, 16, v52
    v_and_b32 v29, s76, v52
    v_add_f32 v25, v25, v28
    v_fmac_f32 v27, v28, v28
    v_mfma_f32_32x32x16_bf16 v[96:111], v[52:55], v[56:59], v[96:111]
    ds_read_b64_tr_b16 v[46:47], v18 offset:17408
    ds_read_b128 v[36:39], v10 offset:36864
    v_add_f32 v25, v25, v29
    v_fmac_f32 v27, v29, v29
    v_lshlrev_b32 v28, 16, v53
    v_and_b32 v29, s76, v53
    v_mfma_f32_32x32x16_bf16 v[112:127], v[52:55], v[60:63], v[112:127]
    v_add_f32 v25, v25, v28
    v_fmac_f32 v27, v28, v28
    v_add_f32 v25, v25, v29
    v_fmac_f32 v27, v29, v29
    s_waitcnt lgkmcnt(3)
    v_mfma_f32_32x32x16_bf16 v[64:79], v[32:35], v[40:43], v[64:79]
    ds_read_b128 v[48:51], v11 offset:32768
    ds_read_b64_tr_b16 v[56:57], v19 offset:0
    v_lshlrev_b32 v28, 16, v34
    v_and_b32 v29, s76, v34
    v_add_f32 v24, v24, v28
    s_waitcnt lgkmcnt(3)
    v_mfma_f32_32x32x16_bf16 v[80:95], v[32:35], v[44:47], v[80:95]
    ds_read_b64_tr_b16 v[58:59], v19 offset:1024
    ds_read_b64_tr_b16 v[60:61], v19 offset:16384
    v_fmac_f32 v26, v28, v28
    v_add_f32 v24, v24, v29
    v_fmac_f32 v26, v29, v29
    s_waitcnt lgkmcnt(4)
    v_mfma_f32_32x32x16_bf16 v[96:111], v[36:39], v[40:43], v[96:111]
    ds_read_b64_tr_b16 v[62:63], v19 offset:17408
    ds_read_b128 v[52:55], v11 offset:36864
    v_lshlrev_b32 v28, 16, v35
    v_and_b32 v29, s76, v35
    v_add_f32 v24, v24, v28
    v_mfma_f32_32x32x16_bf16 v[112:127], v[36:39], v[44:47], v[112:127]
    v_fmac_f32 v26, v28, v28
    v_add_f32 v24, v24, v29
    v_fmac_f32 v26, v29, v29
    v_mov_b32 v30, 0
    buffer_load_dwordx2 v[30:31], v30, s[4:7], 0 offen sc1
    s_waitcnt vmcnt(1) lgkmcnt(0)
    s_barrier
    v_mfma_f32_32x32x16_bf16 v[64:79], v[48:51], v[56:59], v[64:79]
    ds_read_b128 v[32:35], v8 offset:0
    ds_read_b64_tr_b16 v[40:41], v12 offset:0
    v_mfma_f32_32x32x16_bf16 v[80:95], v[48:51], v[60:63], v[80:95]
    ds_read_b64_tr_b16 v[42:43], v12 offset:1024
    ds_read_b64_tr_b16 v[44:45], v12 offset:16384
    v_lshlrev_b32 v28, 16, v54
    v_and_b32 v29, s76, v54
    v_add_f32 v25, v25, v28
    v_fmac_f32 v27, v28, v28
    v_mfma_f32_32x32x16_bf16 v[96:111], v[52:55], v[56:59], v[96:111]
    ds_read_b64_tr_b16 v[46:47], v12 offset:17408
    ds_read_b128 v[36:39], v8 offset:4096
    v_add_f32 v25, v25, v29
    v_fmac_f32 v27, v29, v29
    v_lshlrev_b32 v28, 16, v55
    v_and_b32 v29, s76, v55
    v_mfma_f32_32x32x16_bf16 v[112:127], v[52:55], v[60:63], v[112:127]
    v_add_f32 v25, v25, v28
    v_fmac_f32 v27, v28, v28
    v_add_f32 v25, v25, v29
    v_fmac_f32 v27, v29, v29
    s_waitcnt lgkmcnt(3)
    v_mfma_f32_32x32x16_bf16 v[64:79], v[32:35], v[40:43], v[64:79]
    ds_read_b128 v[48:51], v9 offset:0
    ds_read_b64_tr_b16 v[56:57], v13 offset:0
    v_lshlrev_b32 v28, 16, v32
    v_and_b32 v29, s76, v32
    v_add_f32 v24, v24, v28
    v_fmac_f32 v26, v28, v28
    v_add_f32 v24, v24, v29
    v_fmac_f32 v26, v29, v29
    s_waitcnt lgkmcnt(3)
    v_mfma_f32_32x32x16_bf16 v[80:95], v[32:35], v[44:47], v[80:95]
    ds_read_b64_tr_b16 v[58:59], v13 offset:1024
    ds_read_b64_tr_b16 v[60:61], v13 offset:16384
    v_lshlrev_b32 v28, 16, v33
    v_and_b32 v29, s76, v33
    v_add_f32 v24, v24, v28
    v_fmac_f32 v26, v28, v28
    v_add_f32 v24, v24, v29
    v_fmac_f32 v26, v29, v29
    s_waitcnt lgkmcnt(4)
    v_mfma_f32_32x32x16_bf16 v[96:111], v[36:39], v[40:43], v[96:111]
    ds_read_b64_tr_b16 v[62:63], v13 offset:17408
    ds_read_b128 v[52:55], v9 offset:4096
    v_lshlrev_b32 v28, 16, v34
    v_and_b32 v29, s76, v34
    v_add_f32 v24, v24, v28
    v_fmac_f32 v26, v28, v28
    v_add_f32 v24, v24, v29
    v_fmac_f32 v26, v29, v29
    v_mfma_f32_32x32x16_bf16 v[112:127], v[36:39], v[44:47], v[112:127]
    v_lshlrev_b32 v28, 16, v35
    v_and_b32 v29, s76, v35
    v_add_f32 v24, v24, v28
    v_fmac_f32 v26, v28, v28
    v_add_f32 v24, v24, v29
    v_fmac_f32 v26, v29, v29
    s_waitcnt lgkmcnt(3)
    v_mfma_f32_32x32x16_bf16 v[64:79], v[48:51], v[56:59], v[64:79]
    ds_read_b128 v[32:35], v10 offset:0
    ds_read_b64_tr_b16 v[40:41], v14 offset:0
    s_waitcnt lgkmcnt(2)
    v_mfma_f32_32x32x16_bf16 v[80:95], v[48:51], v[60:63], v[80:95]
    ds_read_b64_tr_b16 v[42:43], v14 offset:1024
    ds_read_b64_tr_b16 v[44:45], v14 offset:16384
    v_lshlrev_b32 v28, 16, v52
    v_and_b32 v29, s76, v52
    v_add_f32 v25, v25, v28
    v_fmac_f32 v27, v28, v28
    v_add_f32 v25, v25, v29
    v_fmac_f32 v27, v29, v29
    v_lshlrev_b32 v28, 16, v53
    v_and_b32 v29, s76, v53
    v_mfma_f32_32x32x16_bf16 v[96:111], v[52:55], v[56:59], v[96:111]
    ds_read_b64_tr_b16 v[46:47], v14 offset:17408
    ds_read_b128 v[36:39], v10 offset:4096
    v_add_f32 v25, v25, v28
    v_fmac_f32 v27, v28, v28
    v_add_f32 v25, v25, v29
    v_fmac_f32 v27, v29, v29
    v_lshlrev_b32 v28, 16, v54
    v_and_b32 v29, s76, v54
    v_add_f32 v25, v25, v28
    v_fmac_f32 v27, v28, v28
    v_mfma_f32_32x32x16_bf16 v[112:127], v[52:55], v[60:63], v[112:127]
    v_add_f32 v25, v25, v29
    v_fmac_f32 v27, v29, v29
    v_lshlrev_b32 v28, 16, v55
    v_and_b32 v29, s76, v55
    v_add_f32 v25, v25, v28
    v_fmac_f32 v27, v28, v28
    v_add_f32 v25, v25, v29
    v_fmac_f32 v27, v29, v29
    s_waitcnt lgkmcnt(3)
    v_mfma_f32_32x32x16_bf16 v[64:79], v[32:35], v[40:43], v[64:79]
    ds_read_b128 v[48:51], v11 offset:0
    ds_read_b64_tr_b16 v[56:57], v15 offset:0
    s_nop 0
    v_permlane32_swap_b32 v24, v25
    v_permlane32_swap_b32 v26, v27
    s_waitcnt lgkmcnt(3)
    v_mfma_f32_32x32x16_bf16 v[80:95], v[32:35], v[44:47], v[80:95]
    ds_read_b64_tr_b16 v[58:59], v15 offset:1024
    ds_read_b64_tr_b16 v[60:61], v15 offset:16384
    v_add_f32 v28, v24, v25
    v_add_f32 v29, v26, v27
    s_waitcnt lgkmcnt(4)
    v_mfma_f32_32x32x16_bf16 v[96:111], v[36:39], v[40:43], v[96:111]
    ds_read_b64_tr_b16 v[62:63], v15 offset:17408
    ds_read_b128 v[52:55], v11 offset:4096
    ds_write_b64 v5, v[28:29]
    v_mfma_f32_32x32x16_bf16 v[112:127], v[36:39], v[44:47], v[112:127]
    s_waitcnt lgkmcnt(0)
    s_barrier
    ds_read_b128 v[32:35], v6
    ds_read_b128 v[36:39], v6 offset:16
    v_mfma_f32_32x32x16_bf16 v[64:79], v[48:51], v[56:59], v[64:79]
    v_mfma_f32_32x32x16_bf16 v[80:95], v[48:51], v[60:63], v[80:95]
    s_waitcnt lgkmcnt(0)
    v_add_f32 v32, v32, v34
    v_add_f32 v33, v33, v35
    v_add_f32 v36, v36, v38
    v_add_f32 v37, v37, v39
    v_add_f32 v32, v32, v36
    v_add_f32 v33, v33, v37
    v_mfma_f32_32x32x16_bf16 v[96:111], v[52:55], v[56:59], v[96:111]
    v_mul_f32 v34, 0xbb124925, v32
    v_mul_f32 v33, 0x3b124925, v33
    v_fma_f32 v33, -v34, v34, v33
    v_max_f32 v33, 0, v33
    v_add_f32 v35, 0x3727c5ac, v33
    v_rsq_f32 v35, v35
    s_nop 0
    ds_write_b32 v7, v35
    v_mfma_f32_32x32x16_bf16 v[112:127], v[52:55], v[60:63], v[112:127]
    ds_read_b128 v[152:155], v3 offset:0
    ds_read_b128 v[156:159], v3 offset:32
    ds_read_b128 v[160:163], v3 offset:64
    ds_read_b128 v[164:167], v3 offset:96
    ds_read_b128 v[168:171], v3 offset:128
    ds_read_b128 v[172:175], v3 offset:160
    ds_read_b128 v[176:179], v3 offset:192
    ds_read_b128 v[180:183], v3 offset:224
    s_sub_u32 s71, s62, 14
    s_lshl_b32 s71, s71, 2
    s_add_u32 s75, s71, s78
    s_sub_u32 s75, s75, 1
    s_lshl_b32 s68, s75, 9
    s_lshl_b32 s71, s61, 1
    s_add_u32 s71, s71, s77
    s_mul_i32 s71, s71, 57344
    s_add_u32 s68, s68, s71
    s_add_u32 s68, s68, 7340032
    v_mul_u32_u24 v5, 14336, v0
    v_lshl_add_u32 v5, v4, 4, v5
    s_lshl_b32 s71, s60, 12
    v_lshl_add_u32 v6, v1, 3, s71
    v_xor_b32 v7, 0x4000, v6
    s_waitcnt lgkmcnt(4)
    v_mul_f32 v64, v64, v152
    v_mul_f32 v65, v65, v153
    v_mul_f32 v66, v66, v154
    v_mul_f32 v67, v67, v155
    v_mul_f32 v68, v68, v156
    v_mul_f32 v69, v69, v157
    v_mul_f32 v70, v70, v158
    v_mul_f32 v71, v71, v159
    v_mul_f32 v72, v72, v160
    v_mul_f32 v73, v73, v161
    v_mul_f32 v74, v74, v162
    v_mul_f32 v75, v75, v163
    v_mul_f32 v76, v76, v164
    v_mul_f32 v77, v77, v165
    v_mul_f32 v78, v78, v166
    v_mul_f32 v79, v79, v167
    v_cvt_pk_bf16_f32 v32, v64, v65
    v_cvt_pk_bf16_f32 v33, v66, v67
    v_cvt_pk_bf16_f32 v34, v68, v69
    v_cvt_pk_bf16_f32 v35, v70, v71
    v_cvt_pk_bf16_f32 v36, v72, v73
    v_cvt_pk_bf16_f32 v37, v74, v75
    v_cvt_pk_bf16_f32 v38, v76, v77
    v_cvt_pk_bf16_f32 v39, v78, v79
    v_mul_f32 v80, v80, v152
    v_mul_f32 v81, v81, v153
    v_mul_f32 v82, v82, v154
    v_mul_f32 v83, v83, v155
    v_mul_f32 v84, v84, v156
    v_mul_f32 v85, v85, v157
    v_mul_f32 v86, v86, v158
    v_mul_f32 v87, v87, v159
    v_mul_f32 v88, v88, v160
    v_mul_f32 v89, v89, v161
    v_mul_f32 v90, v90, v162
    v_mul_f32 v91, v91, v163
    v_mul_f32 v92, v92, v164
    v_mul_f32 v93, v93, v165
    v_mul_f32 v94, v94, v166
    v_mul_f32 v95, v95, v167
    v_cvt_pk_bf16_f32 v40, v80, v81
    v_cvt_pk_bf16_f32 v41, v82, v83
    v_cvt_pk_bf16_f32 v42, v84, v85
    v_cvt_pk_bf16_f32 v43, v86, v87
    v_cvt_pk_bf16_f32 v44, v88, v89
    v_cvt_pk_bf16_f32 v45, v90, v91
    v_cvt_pk_bf16_f32 v46, v92, v93
    v_cvt_pk_bf16_f32 v47, v94, v95
    s_nop 1
    v_mfma_f32_32x32x16_bf16 v[64:79], v[128:131], v[32:35], 0
    s_waitcnt lgkmcnt(0)
    v_mul_f32 v96, v96, v168
    v_mul_f32 v97, v97, v169
    v_mul_f32 v98, v98, v170
    v_mul_f32 v99, v99, v171
    v_mul_f32 v100, v100, v172
    v_mul_f32 v101, v101, v173
    v_mfma_f32_32x32x16_bf16 v[80:95], v[136:139], v[32:35], 0
    v_mul_f32 v102, v102, v174
    v_mul_f32 v103, v103, v175
    v_mul_f32 v104, v104, v176
    v_mul_f32 v105, v105, v177
    v_mul_f32 v106, v106, v178
    v_mul_f32 v107, v107, v179
    v_mfma_f32_32x32x16_bf16 v[64:79], v[132:135], v[36:39], v[64:79]
    v_mul_f32 v108, v108, v180
    v_mul_f32 v109, v109, v181
    v_mul_f32 v110, v110, v182
    v_mul_f32 v111, v111, v183
    v_cvt_pk_bf16_f32 v48, v96, v97
    v_cvt_pk_bf16_f32 v49, v98, v99
    v_mfma_f32_32x32x16_bf16 v[80:95], v[140:143], v[36:39], v[80:95]
    v_cvt_pk_bf16_f32 v50, v100, v101
    v_cvt_pk_bf16_f32 v51, v102, v103
    v_cvt_pk_bf16_f32 v52, v104, v105
    v_cvt_pk_bf16_f32 v53, v106, v107
    v_cvt_pk_bf16_f32 v54, v108, v109
    v_cvt_pk_bf16_f32 v55, v110, v111
    v_mfma_f32_32x32x16_bf16 v[64:79], v[144:147], v[40:43], v[64:79]
    v_mul_f32 v112, v112, v168
    v_mul_f32 v113, v113, v169
    v_mul_f32 v114, v114, v170
    v_mul_f32 v115, v115, v171
    v_mul_f32 v116, v116, v172
    v_mul_f32 v117, v117, v173
    v_mul_f32 v118, v118, v174
    v_mfma_f32_32x32x16_bf16 v[80:95], v[128:131], v[40:43], v[80:95]
    v_mul_f32 v119, v119, v175
    v_mul_f32 v120, v120, v176
    v_mul_f32 v121, v121, v177
    v_mul_f32 v122, v122, v178
    v_mul_f32 v123, v123, v179
    v_mul_f32 v124, v124, v180
    v_mfma_f32_32x32x16_bf16 v[64:79], v[148:151], v[44:47], v[64:79]
    v_mul_f32 v125, v125, v181
    v_mul_f32 v126, v126, v182
    v_mul_f32 v127, v127, v183
    v_cvt_pk_bf16_f32 v56, v112, v113
    v_cvt_pk_bf16_f32 v57, v114, v115
    v_cvt_pk_bf16_f32 v58, v116, v117
    v_mfma_f32_32x32x16_bf16 v[80:95], v[132:135], v[44:47], v[80:95]
    v_cvt_pk_bf16_f32 v59, v118, v119
    v_cvt_pk_bf16_f32 v60, v120, v121
    v_cvt_pk_bf16_f32 v61, v122, v123
    v_cvt_pk_bf16_f32 v62, v124, v125
    v_cvt_pk_bf16_f32 v63, v126, v127
    s_nop 1
    v_mfma_f32_32x32x16_bf16 v[96:111], v[128:131], v[48:51], 0
    v_mfma_f32_32x32x16_bf16 v[112:127], v[136:139], v[48:51], 0
    v_mfma_f32_32x32x16_bf16 v[96:111], v[132:135], v[52:55], v[96:111]
    v_mfma_f32_32x32x16_bf16 v[112:127], v[140:143], v[52:55], v[112:127]
    v_mfma_f32_32x32x16_bf16 v[96:111], v[144:147], v[56:59], v[96:111]
    v_mfma_f32_32x32x16_bf16 v[112:127], v[128:131], v[56:59], v[112:127]
    v_mfma_f32_32x32x16_bf16 v[96:111], v[148:151], v[60:63], v[96:111]
    v_mfma_f32_32x32x16_bf16 v[112:127], v[132:135], v[60:63], v[112:127]
    s_nop 13
    s_cmp_eq_u32 s77, 0
    s_cbranch_scc0 kd_r1
    v_cvt_pk_bf16_f32 v184, v72, v104
    v_cvt_pk_bf16_f32 v185, v88, v120
    ds_write_b64 v6, v[184:185] offset:0
    v_cvt_pk_bf16_f32 v186, v73, v105
    v_cvt_pk_bf16_f32 v187, v89, v121
    ds_write_b64 v6, v[186:187] offset:512
    v_cvt_pk_bf16_f32 v188, v74, v106
    v_cvt_pk_bf16_f32 v189, v90, v122
    ds_write_b64 v6, v[188:189] offset:1024
    v_cvt_pk_bf16_f32 v190, v75, v107
    v_cvt_pk_bf16_f32 v191, v91, v123
    ds_write_b64 v6, v[190:191] offset:1536
    v_cvt_pk_bf16_f32 v192, v76, v108
    v_cvt_pk_bf16_f32 v193, v92, v124
    ds_write_b64 v6, v[192:193] offset:2048
    v_cvt_pk_bf16_f32 v194, v77, v109
    v_cvt_pk_bf16_f32 v195, v93, v125
    ds_write_b64 v6, v[194:195] offset:2560
    v_cvt_pk_bf16_f32 v196, v78, v110
    v_cvt_pk_bf16_f32 v197, v94, v126
    ds_write_b64 v6, v[196:197] offset:3072
    v_cvt_pk_bf16_f32 v198, v79, v111
    v_cvt_pk_bf16_f32 v199, v95, v127
    ds_write_b64 v6, v[198:199] offset:3584
    v_cvt_pk_bf16_f32 v32, v64, v96
    v_cvt_pk_bf16_f32 v33, v80, v112
    v_cvt_pk_bf16_f32 v36, v65, v97
    v_cvt_pk_bf16_f32 v37, v81, v113
    v_cvt_pk_bf16_f32 v40, v66, v98
    v_cvt_pk_bf16_f32 v41, v82, v114
    v_cvt_pk_bf16_f32 v44, v67, v99
    v_cvt_pk_bf16_f32 v45, v83, v115
    v_cvt_pk_bf16_f32 v48, v68, v100
    v_cvt_pk_bf16_f32 v49, v84, v116
    v_cvt_pk_bf16_f32 v52, v69, v101
    v_cvt_pk_bf16_f32 v53, v85, v117
    v_cvt_pk_bf16_f32 v56, v70, v102
    v_cvt_pk_bf16_f32 v57, v86, v118
    v_cvt_pk_bf16_f32 v60, v71, v103
    v_cvt_pk_bf16_f32 v61, v87, v119
    s_waitcnt lgkmcnt(0)
    s_barrier
    ds_read_b64 v[34:35], v7 offset:0
    ds_read_b64 v[38:39], v7 offset:512
    ds_read_b64 v[42:43], v7 offset:1024
    ds_read_b64 v[46:47], v7 offset:1536
    ds_read_b64 v[50:51], v7 offset:2048
    ds_read_b64 v[54:55], v7 offset:2560
    ds_read_b64 v[58:59], v7 offset:3072
    ds_read_b64 v[62:63], v7 offset:3584
    s_branch kd_st
kd_r1:
    v_cvt_pk_bf16_f32 v184, v64, v96
    v_cvt_pk_bf16_f32 v185, v80, v112
    ds_write_b64 v6, v[184:185] offset:0
    v_cvt_pk_bf16_f32 v186, v65, v97
    v_cvt_pk_bf16_f32 v187, v81, v113
    ds_write_b64 v6, v[186:187] offset:512
    v_cvt_pk_bf16_f32 v188, v66, v98
    v_cvt_pk_bf16_f32 v189, v82, v114
    ds_write_b64 v6, v[188:189] offset:1024
    v_cvt_pk_bf16_f32 v190, v67, v99
    v_cvt_pk_bf16_f32 v191, v83, v115
    ds_write_b64 v6, v[190:191] offset:1536
    v_cvt_pk_bf16_f32 v192, v68, v100
    v_cvt_pk_bf16_f32 v193, v84, v116
    ds_write_b64 v6, v[192:193] offset:2048
    v_cvt_pk_bf16_f32 v194, v69, v101
    v_cvt_pk_bf16_f32 v195, v85, v117
    ds_write_b64 v6, v[194:195] offset:2560
    v_cvt_pk_bf16_f32 v196, v70, v102
    v_cvt_pk_bf16_f32 v197, v86, v118
    ds_write_b64 v6, v[196:197] offset:3072
    v_cvt_pk_bf16_f32 v198, v71, v103
    v_cvt_pk_bf16_f32 v199, v87, v119
    ds_write_b64 v6, v[198:199] offset:3584
    v_cvt_pk_bf16_f32 v34, v72, v104
    v_cvt_pk_bf16_f32 v35, v88, v120
    v_cvt_pk_bf16_f32 v38, v73, v105
    v_cvt_pk_bf16_f32 v39, v89, v121
    v_cvt_pk_bf16_f32 v42, v74, v106
    v_cvt_pk_bf16_f32 v43, v90, v122
    v_cvt_pk_bf16_f32 v46, v75, v107
    v_cvt_pk_bf16_f32 v47, v91, v123
    v_cvt_pk_bf16_f32 v50, v76, v108
    v_cvt_pk_bf16_f32 v51, v92, v124
    v_cvt_pk_bf16_f32 v54, v77, v109
    v_cvt_pk_bf16_f32 v55, v93, v125
    v_cvt_pk_bf16_f32 v58, v78, v110
    v_cvt_pk_bf16_f32 v59, v94, v126
    v_cvt_pk_bf16_f32 v62, v79, v111
    v_cvt_pk_bf16_f32 v63, v95, v127
    s_waitcnt lgkmcnt(0)
    s_barrier
    ds_read_b64 v[32:33], v7 offset:0
    ds_read_b64 v[36:37], v7 offset:512
    ds_read_b64 v[40:41], v7 offset:1024
    ds_read_b64 v[44:45], v7 offset:1536
    ds_read_b64 v[48:49], v7 offset:2048
    ds_read_b64 v[52:53], v7 offset:2560
    ds_read_b64 v[56:57], v7 offset:3072
    ds_read_b64 v[60:61], v7 offset:3584
kd_st:
    s_cmp_ge_u32 s75, 7
    s_cbranch_scc1 kd_end
    s_waitcnt lgkmcnt(7)
    buffer_store_dwordx4 v[32:35], v5, s[52:55], s68 offen sc1
    s_add_u32 s68, s68, 3584
    s_waitcnt lgkmcnt(6)
    buffer_store_dwordx4 v[36:39], v5, s[52:55], s68 offen sc1
    s_add_u32 s68, s68, 3584
    s_waitcnt lgkmcnt(5)
    buffer_store_dwordx4 v[40:43], v5, s[52:55], s68 offen sc1
    s_add_u32 s68, s68, 3584
    s_waitcnt lgkmcnt(4)
    buffer_store_dwordx4 v[44:47], v5, s[52:55], s68 offen sc1
    s_add_u32 s68, s68, 17920
    s_waitcnt lgkmcnt(3)
    buffer_store_dwordx4 v[48:51], v5, s[52:55], s68 offen sc1
    s_add_u32 s68, s68, 3584
    s_waitcnt lgkmcnt(2)
    buffer_store_dwordx4 v[52:55], v5, s[52:55], s68 offen sc1
    s_add_u32 s68, s68, 3584
    s_waitcnt lgkmcnt(1)
    buffer_store_dwordx4 v[56:59], v5, s[52:55], s68 offen sc1
    s_add_u32 s68, s68, 3584
    s_waitcnt lgkmcnt(0)
    buffer_store_dwordx4 v[60:63], v5, s[52:55], s68 offen sc1
kd_end:
    s_waitcnt vmcnt(0) lgkmcnt(0)
    s_barrier
    s_cmp_lg_u32 s60, 0
    s_cbranch_scc1 kd_fin
    s_mov_b32 s71, 0
kd_nchk:
    v_readfirstlane_b32 s18, v30
    v_readfirstlane_b32 s19, v31
    s_cmp_lg_u64 s[18:19], 0
    s_cbranch_scc1 kd_nok
    buffer_load_dwordx2 v[30:31], v30, s[4:7], 0 offen sc1
    s_add_u32 s71, s71, 1
    s_cmp_gt_u32 s71, 262144
    s_waitcnt vmcnt(0)
    s_cbranch_scc0 kd_nchk
kd_nok:
    s_lshl_b32 s71, s61, 4
    s_add_u32 s71, s71, s62
    s_lshl_b32 s71, s71, 10
    s_add_u32 s71, s71, 9437184
    v_lshlrev_b32 v28, 3, v1
    s_mov_b64 exec, 0xffff
    buffer_store_dwordx2 v[30:31], v28, s[52:55], s71 offen sc0 sc1
    s_mov_b64 exec, -1
kd_fin:
    s_endpgm
k_done:
    s_endpgm
.section .rodata,"a"
.p2align 6
.amdhsa_kernel recurrent_scan__spectral_fnet__geglu_ffn__prompt_kernel
  .amdhsa_next_free_vgpr 256
  .amdhsa_next_free_sgpr 102
  .amdhsa_accum_offset 256
  .amdhsa_group_segment_fixed_size 0
  .amdhsa_kernarg_size 96
  .amdhsa_user_sgpr_count 2
  .amdhsa_user_sgpr_kernarg_segment_ptr 1
  .amdhsa_system_sgpr_workgroup_id_x 1
.end_amdhsa_kernel
```
